```python
import torch

def _softmax(x, axis=-1):
    return torch.softmax(x, dim=axis)
def _gelu(x):
    return torch.nn.functional.gelu(x, approximate="tanh")
def _silu(x):
    return torch.nn.functional.silu(x)
def _sigmoid(x):
    return torch.sigmoid(x)
def _layernorm(x, axis=-1, eps=1e-5):
    m = x.mean(dim=axis, keepdim=True)
    v = x.var(dim=axis, keepdim=True, unbiased=False)
    return (x - m) / torch.sqrt(v + eps)
def _scatter_add(tgt, idx, src, axis=0):
    return tgt.clone().index_add_(axis, idx, src)
def _segment_sum(src, seg, n):
    out = torch.zeros((n,) + src.shape[1:], dtype=src.dtype)
    return out.index_add_(0, seg, src)
def _pad(x, pw):
    flat = tuple(v for pair in reversed(pw) for v in pair)
    return torch.nn.functional.pad(x, flat)

kernel_name = 'recurrent_scan__spectral_fnet__mixer_channel_mlp__prompt'

def setup_inputs():

    _w = (lambda a: (lambda t: t.to(torch.bfloat16) if t.is_floating_point() else t)(torch.as_tensor(a)))
    def _A_setup():
        B, S, D = 1, 2048, 512
        ns = torch.arange(S)[:, None] * torch.arange(S)[None, :]
        nd = torch.arange(D)[:, None] * torch.arange(D)[None, :]
        Ws_re = torch.cos(-2.0 * torch.pi * ns / S).to(float)
        Ws_im = torch.sin(-2.0 * torch.pi * ns / S).to(float)
        Wd_re = torch.cos(-2.0 * torch.pi * nd / D).to(float)
        Wd_im = torch.sin(-2.0 * torch.pi * nd / D).to(float)
        return {
            "x": _w((lambda *s: torch.randn(*s, dtype=torch.bfloat16) * 0.05)(B, S, D)),
            "dft_seq_re": _w(Ws_re),
            "dft_seq_im": _w(Ws_im),
            "dft_hid_re": _w(Wd_re),
            "dft_hid_im": _w(Wd_im),
        }
    _A_in = _A_setup()

    def _B_setup():
        B, S, D, F = 1, 2048, 512, 1376
        return {
            "x": _w((lambda *s: torch.randn(*s, dtype=torch.bfloat16) * 0.05)(B, S, D)),
            "w1": _w((lambda *s: torch.randn(*s, dtype=torch.bfloat16) * 0.8)(D, F) * (D ** -0.5)),
            "b1": _w((lambda *s: torch.randn(*s, dtype=torch.bfloat16) * 0.8)(F)),
            "w2": _w((lambda *s: torch.randn(*s, dtype=torch.bfloat16) * 0.05)(F, D) * (F ** -0.5)),
            "b2": _w((lambda *s: torch.randn(*s, dtype=torch.bfloat16) * 0.05)(D)),
        }
    _B_in = _B_setup()

    return {
        "A_x": _A_in["x"],
        "A_dft_seq_re": _A_in["dft_seq_re"],
        "A_dft_seq_im": _A_in["dft_seq_im"],
        "A_dft_hid_re": _A_in["dft_hid_re"],
        "A_dft_hid_im": _A_in["dft_hid_im"],
        "B_x": _B_in["x"],
        "B_w1": _B_in["w1"],
        "B_b1": _B_in["b1"],
        "B_w2": _B_in["w2"],
        "B_b2": _B_in["b2"],
    }

def reference(A_x, A_dft_seq_re, A_dft_seq_im, A_dft_hid_re, A_dft_hid_im, B_x, B_w1, B_b1, B_w2, B_b2):
    def _A_ref(x, dft_seq_re, dft_seq_im, dft_hid_re, dft_hid_im):
        a = torch.einsum("bsd,ed->bse", x, dft_hid_re)
        b = torch.einsum("bsd,ed->bse", x, dft_hid_im)
        y = torch.einsum("ts,bse->bte", dft_seq_re, a) - torch.einsum("ts,bse->bte", dft_seq_im, b)
        return y

    def _B_ref(x, w1, b1, w2, b2):
        y = _layernorm(x, axis=-1)
        h = _gelu(torch.einsum("bsd,df->bsf", y, w1) + b1)
        return torch.einsum("bsf,fd->bsd", h, w2) + b2

    x = A_x
    xn = _layernorm(x, axis=-1)
    s = _A_ref(xn, A_dft_seq_re, A_dft_seq_im, A_dft_hid_re, A_dft_hid_im)
    g = _silu(_B_ref(xn, B_w1, B_b1, B_w2, B_b2))
    return x + s * g
```

```asm
; @launch grid=(256,1,1) block=(512,1,1) lds=163840
.amdgcn_target "amdgcn-amd-amdhsa--gfx950"
.text
.globl recurrent_scan__spectral_fnet__mixer_channel_mlp__prompt_kernel
.p2align 8
.type recurrent_scan__spectral_fnet__mixer_channel_mlp__prompt_kernel,@function
recurrent_scan__spectral_fnet__mixer_channel_mlp__prompt_kernel:
    s_cmp_ge_u32 s2, 256
    s_cbranch_scc1 L_END
    s_load_dwordx2 s[4:5], s[0:1], 0
    s_load_dwordx8 s[16:23], s[0:1], 48
    s_load_dwordx4 s[24:27], s[0:1], 80
    s_load_dwordx2 s[28:29], s[0:1], 96
    s_lshr_b32 s41, s2, 3
    s_getpc_b64 s[60:61]
L_PC:
    v_cmp_gt_u32 vcc, 8, v0
    s_mul_i32 s42, s41, 1024
    v_lshlrev_b32 v3, 7, v0
    s_and_b32 s61, s61, 0xffff
    s_mov_b32 s62, L_FIN-L_PC
    s_mov_b32 s63, 0x20000
    v_add_u32 v3, s42, v3
    s_mov_b64 exec, vcc
    buffer_load_dword v255, v3, s[60:63], 0 offen
    s_mov_b64 exec, -1
    v_and_b32 v1, 63, v0
    v_lshrrev_b32 v2, 6, v0
    s_and_b32 s40, s2, 7
    v_readfirstlane_b32 s30, v2
    s_and_b32 s42, s41, 1
    s_lshl1_add_u32 s31, s40, s42
    s_lshr_b32 s32, s41, 1
    s_lshr_b32 s3, s40, 1
    s_lshl1_add_u32 s3, s3, s42
    s_and_b32 s43, s40, 1
    s_lshl_b32 s3, s3, 6
    s_or_b32 s3, s3, s43
    s_lshr_b32 s38, s32, 3
    s_and_b32 s39, s32, 7
    s_mul_i32 s36, s32, 3
    s_lshl1_add_u32 s40, s32, 11
    s_min_u32 s36, s36, s40
    s_and_b32 s33, s30, 3
    s_mov_b32 s35, 0
    s_cmp_ge_u32 s30, 4
    s_cbranch_scc1 L_C
    v_lshrrev_b32 v16, 5, v1
    v_bfe_u32 v17, v1, 3, 2
    v_lshrrev_b32 v18, 4, v1
    v_and_b32 v19, 7, v1
    v_xor_b32 v18, v18, v19
    v_lshlrev_b32 v18, 4, v18
    s_lshl4_add_u32 s40, s33, s3

    v_lshl_add_u32 v16, v16, 3, s40
    v_add_u32 v19, 1, v17
    v_lshrrev_b32 v19, 1, v19
    v_lshl_add_u32 v19, v19, 20, v18
    v_cmp_lt_u32 vcc, 1, v17
    v_mov_b32 v20, 1024
    v_mov_b32 v21, -1024
    v_cndmask_b32 v20, v20, v21, vcc
    v_mad_i32_i24 v4, v20, v16, v19
    v_lshl_add_u32 v5, v20, 1, v4
    v_xor_b32 v5, 64, v5
    v_lshl_add_u32 v6, v20, 2, v4
    v_lshl_add_u32 v7, v20, 2, v5
    s_cmp_lg_u32 s40, 0
    s_cbranch_scc1 L_MNS
    s_movk_i32 s41, 0x2130
    v_lshlrev_b32 v19, 2, v17
    v_lshrrev_b32_e64 v19, v19, s41
    v_and_b32 v19, 15, v19
    s_mov_b32 exec_hi, 0
    v_lshl_add_u32 v4, v19, 19, v18
    s_mov_b32 exec_hi, -1
L_MNS:
    s_lshl_b32 s88, s33, 12
    s_mul_i32 s89, s33, 3072
    s_add_u32 s89, s89, 16384
    s_movk_i32 s41, 5462
    s_movk_i32 s42, 2560
    v_lshlrev_b32 v0, 4, v1
    v_mul_u32_u24 v17, s41, v1
    v_lshrrev_b32 v17, 16, v17
    v_lshlrev_b32 v18, 4, v1
    v_mad_u32_u24 v8, v17, s42, v18
    v_add_u32 v16, 64, v1
    v_mul_u32_u24 v17, s41, v16
    v_lshrrev_b32 v17, 16, v17
    v_lshlrev_b32 v18, 4, v16
    v_mad_u32_u24 v9, v17, s42, v18
    v_add_u32 v16, 128, v1
    v_mul_u32_u24 v17, s41, v16
    v_lshrrev_b32 v17, 16, v17
    v_lshlrev_b32 v18, 4, v16
    v_mad_u32_u24 v10, v17, s42, v18
    s_lshl_b32 s40, s36, 6
    s_mul_i32 s41, s33, 44032
    s_add_u32 s40, s40, s41
    s_waitcnt lgkmcnt(0)
    s_mov_b32 s48, s4
    s_and_b32 s49, s5, 0xffff
    s_mov_b32 s50, 2097152
    s_mov_b32 s51, 0x20000
    s_movk_i32 s90, 512
    s_add_u32 m0, s88, 0
    s_nop 0
    buffer_load_dwordx4 v4, s[48:51], s90 offen lds
    s_add_u32 m0, s88, 1024
    s_nop 0
    buffer_load_dwordx4 v5, s[48:51], s90 offen lds
    s_add_u32 m0, s88, 2048
    s_nop 0
    buffer_load_dwordx4 v6, s[48:51], s90 offen lds
    s_add_u32 m0, s88, 3072
    s_nop 0
    buffer_load_dwordx4 v7, s[48:51], s90 offen lds
    s_add_u32 s52, s16, s40
    s_addc_u32 s53, s17, 0
    s_and_b32 s53, s53, 0xffff
    s_sub_u32 s54, 1409024, s40
    s_mov_b32 s55, 0x20000
    s_mov_b32 s91, 704512
    s_add_u32 m0, s89, 0
    s_nop 0
    buffer_load_dwordx4 v8, s[52:55], s91 offen lds
    s_add_u32 m0, s89, 1024
    s_nop 0
    buffer_load_dwordx4 v9, s[52:55], s91 offen lds
    s_add_u32 m0, s89, 2048
    s_nop 0
    buffer_load_dwordx4 v10, s[52:55], s91 offen lds
    s_movk_i32 s90, 640
    s_add_u32 m0, s88, 28672
    s_nop 0
    buffer_load_dwordx4 v4, s[48:51], s90 offen lds
    s_add_u32 m0, s88, 29696
    s_nop 0
    buffer_load_dwordx4 v5, s[48:51], s90 offen lds
    s_add_u32 m0, s88, 30720
    s_nop 0
    buffer_load_dwordx4 v6, s[48:51], s90 offen lds
    s_add_u32 m0, s88, 31744
    s_nop 0
    buffer_load_dwordx4 v7, s[48:51], s90 offen lds
    s_mov_b32 s91, 880640
    s_add_u32 m0, s89, 28672
    s_nop 0
    buffer_load_dwordx4 v8, s[52:55], s91 offen lds
    s_add_u32 m0, s89, 29696
    s_nop 0
    buffer_load_dwordx4 v9, s[52:55], s91 offen lds
    s_add_u32 m0, s89, 30720
    s_nop 0
    buffer_load_dwordx4 v10, s[52:55], s91 offen lds
    s_movk_i32 s90, 768
    s_add_u32 m0, s88, 57344
    s_nop 0
    buffer_load_dwordx4 v4, s[48:51], s90 offen lds
    s_add_u32 m0, s88, 58368
    s_nop 0
    buffer_load_dwordx4 v5, s[48:51], s90 offen lds
    s_add_u32 m0, s88, 59392
    s_nop 0
    buffer_load_dwordx4 v6, s[48:51], s90 offen lds
    s_add_u32 m0, s88, 60416
    s_nop 0
    buffer_load_dwordx4 v7, s[48:51], s90 offen lds
    s_mov_b32 s91, 1056768
    s_add_u32 m0, s89, 57344
    s_nop 0
    buffer_load_dwordx4 v8, s[52:55], s91 offen lds
    s_add_u32 m0, s89, 58368
    s_nop 0
    buffer_load_dwordx4 v9, s[52:55], s91 offen lds
    s_add_u32 m0, s89, 59392
    s_nop 0
    buffer_load_dwordx4 v10, s[52:55], s91 offen lds
    s_mov_b32 s44, s28
    s_and_b32 s45, s29, 0xffff
    s_mov_b32 s46, 268435456
    s_mov_b32 s47, 0x20000
    v_and_b32 v16, 31, v1
    s_cmp_lt_u32 s33, 3
    s_cselect_b32 s40, 21, 19
    v_min_u32 v24, s40, v16
    s_lshr_b32 s40, s39, 1
    s_sub_u32 s41, 7, s40
    s_mul_i32 s40, s40, 96
    s_mul_i32 s41, s41, 96
    v_mov_b32 v17, s41
    v_mov_b32 v18, s40
    v_cmp_gt_u32 vcc, 32, v1
    s_mul_i32 s42, s33, 22
    s_nop 0
    v_cndmask_b32 v17, v17, v18, vcc
    v_add3_u32 v24, v24, v17, s42
    v_lshlrev_b32 v24, 2, v24
    v_add_u32 v24, 32768, v24
    s_lshl_b32 s41, s42, 11
    s_mul_i32 s40, s39, 176128
    s_add_u32 s40, s40, s41
    s_add_u32 s92, s40, 10485760
    s_lshl1_add_u32 s40, s31, s38
    s_mul_i32 s40, s40, 176128
    s_add_u32 s40, s40, s41
    s_add_u32 s93, s40, 4194304
    s_lshl_b32 s94, s33, 15
    v_add_u32 v2, s94, v0
    s_mul_i32 s40, s31, 44
    s_mul_i32 s41, s33, 11
    s_add_u32 s41, s41, s40
    s_lshl_b32 s41, s41, 4
    v_add_u32 v3, s41, v0
    s_lshr_b32 s41, s32, 2
    s_mul_i32 s41, s41, 11
    s_and_b32 s42, s32, 3
    s_add_u32 s41, s41, s42
    s_add_u32 s41, s41, s40
    s_lshl_b32 s41, s41, 4
    v_writelane_b32 v3, s41, 11
    s_cmp_lt_u32 s33, 3
    s_movk_i32 s95, 0xbff
    s_cselect_b32 s95, 0xfff, s95
    v_mov_b32 v19, 163584
    s_lshr_b32 s40, s32, 2
    s_mul_i32 s40, s40, 11
    s_and_b32 s41, s32, 3
    s_add_u32 s40, s40, s41
    s_and_b32 s41, s33, 1
    s_lshl2_add_u32 s40, s41, s40
    s_mul_i32 s41, s32, 11
    s_lshr_b32 s41, s41, 5
    s_lshl3_add_u32 s41, s41, s32
    s_add_u32 s41, s41, 8
    s_cmp_lt_u32 s32, 11
    s_cselect_b32 s41, s41, s40
    s_cmp_eq_u32 s33, 2
    s_cselect_b32 s40, s41, s40
    s_lshl_b32 s40, s40, 12
    s_mul_i32 s41, s31, 352256
    s_add_u32 s40, s40, s41
    s_add_u32 s40, s40, 4194304
    v_lshrrev_b32 v27, 5, v1
    v_mul_u32_u24 v27, 176128, v27
    v_lshl_add_u32 v26, v16, 7, s40
    v_add_u32 v26, v26, v27
    s_waitcnt vmcnt(14)
    s_barrier
    s_movk_i32 s90, 896
    s_add_u32 m0, s88, 86016
    s_nop 0
    buffer_load_dwordx4 v4, s[48:51], s90 offen lds
    s_add_u32 m0, s88, 87040
    s_nop 0
    buffer_load_dwordx4 v5, s[48:51], s90 offen lds
    s_add_u32 m0, s88, 88064
    s_nop 0
    buffer_load_dwordx4 v6, s[48:51], s90 offen lds
    s_add_u32 m0, s88, 89088
    s_nop 0
    buffer_load_dwordx4 v7, s[48:51], s90 offen lds
    s_mov_b32 s91, 1232896
    s_add_u32 m0, s89, 86016
    s_nop 0
    buffer_load_dwordx4 v8, s[52:55], s91 offen lds
    s_add_u32 m0, s89, 87040
    s_nop 0
    buffer_load_dwordx4 v9, s[52:55], s91 offen lds
    s_add_u32 m0, s89, 88064
    s_nop 0
    buffer_load_dwordx4 v10, s[52:55], s91 offen lds
    s_waitcnt vmcnt(14)
    s_barrier
    ds_read_b32 v20, v19
    s_movk_i32 s90, 0
    s_add_u32 m0, s88, 131072
    s_nop 0
    buffer_load_dwordx4 v4, s[48:51], s90 offen lds
    s_add_u32 m0, s88, 132096
    s_nop 0
    buffer_load_dwordx4 v5, s[48:51], s90 offen lds
    s_add_u32 m0, s88, 133120
    s_nop 0
    buffer_load_dwordx4 v6, s[48:51], s90 offen lds
    s_add_u32 m0, s88, 134144
    s_nop 0
    buffer_load_dwordx4 v7, s[48:51], s90 offen lds
    s_mov_b32 s91, 0
    s_add_u32 m0, s89, 131072
    s_nop 0
    buffer_load_dwordx4 v8, s[52:55], s91 offen lds
    s_add_u32 m0, s89, 132096
    s_nop 0
    buffer_load_dwordx4 v9, s[52:55], s91 offen lds
    s_add_u32 m0, s89, 133120
    s_nop 0
    buffer_load_dwordx4 v10, s[52:55], s91 offen lds
    s_waitcnt vmcnt(14)
    s_barrier
    s_waitcnt lgkmcnt(0)
    v_readfirstlane_b32 s35, v20
    s_movk_i32 s90, 128
    s_add_u32 m0, s88, 0
    s_nop 0
    buffer_load_dwordx4 v4, s[48:51], s90 offen lds
    s_add_u32 m0, s88, 1024
    s_nop 0
    buffer_load_dwordx4 v5, s[48:51], s90 offen lds
    s_add_u32 m0, s88, 2048
    s_nop 0
    buffer_load_dwordx4 v6, s[48:51], s90 offen lds
    s_add_u32 m0, s88, 3072
    s_nop 0
    buffer_load_dwordx4 v7, s[48:51], s90 offen lds
    s_mov_b32 s91, 176128
    s_add_u32 m0, s89, 0
    s_nop 0
    buffer_load_dwordx4 v8, s[52:55], s91 offen lds
    s_add_u32 m0, s89, 1024
    s_nop 0
    buffer_load_dwordx4 v9, s[52:55], s91 offen lds
    s_add_u32 m0, s89, 2048
    s_nop 0
    buffer_load_dwordx4 v10, s[52:55], s91 offen lds
    s_waitcnt vmcnt(14)
    s_barrier
    s_movk_i32 s90, 256
    s_add_u32 m0, s88, 28672
    s_nop 0
    buffer_load_dwordx4 v4, s[48:51], s90 offen lds
    s_add_u32 m0, s88, 29696
    s_nop 0
    buffer_load_dwordx4 v5, s[48:51], s90 offen lds
    s_add_u32 m0, s88, 30720
    s_nop 0
    buffer_load_dwordx4 v6, s[48:51], s90 offen lds
    s_add_u32 m0, s88, 31744
    s_nop 0
    buffer_load_dwordx4 v7, s[48:51], s90 offen lds
    s_mov_b32 s91, 352256
    s_add_u32 m0, s89, 28672
    s_nop 0
    buffer_load_dwordx4 v8, s[52:55], s91 offen lds
    s_add_u32 m0, s89, 29696
    s_nop 0
    buffer_load_dwordx4 v9, s[52:55], s91 offen lds
    s_add_u32 m0, s89, 30720
    s_nop 0
    buffer_load_dwordx4 v10, s[52:55], s91 offen lds
    s_waitcnt vmcnt(14)
    s_barrier
    s_cmp_lg_u32 s32, 8
    s_cbranch_scc1 L_MNZ
    v_and_b32 v36, 1, v1
    v_mul_u32_u24 v36, 540672, v36
    v_bfe_u32 v37, v1, 1, 1
    v_lshl_add_u32 v36, v37, 12, v36
    s_lshl2_add_u32 s40, s31, s33
    s_mul_i32 s40, s40, 4224
    s_add_u32 s40, s40, 1318912
    v_mov_b32 v32, 0
    v_mov_b32 v33, 0
    v_mov_b32 v34, 0
    v_mov_b32 v35, 0
    s_mov_b64 exec, 15
    buffer_store_dwordx4 v[32:35], v36, s[44:47], s40 offen sc1
    s_mov_b64 exec, -1
L_MNZ:
    s_movk_i32 s90, 384
    s_add_u32 m0, s88, 57344
    s_nop 0
    buffer_load_dwordx4 v4, s[48:51], s90 offen lds
    s_add_u32 m0, s88, 58368
    s_nop 0
    buffer_load_dwordx4 v5, s[48:51], s90 offen lds
    s_add_u32 m0, s88, 59392
    s_nop 0
    buffer_load_dwordx4 v6, s[48:51], s90 offen lds
    s_add_u32 m0, s88, 60416
    s_nop 0
    buffer_load_dwordx4 v7, s[48:51], s90 offen lds
    buffer_load_dword v25, v24, s[44:47], 0 offen sc1
    s_mov_b32 s91, 528384
    s_add_u32 m0, s89, 57344
    s_nop 0
    buffer_load_dwordx4 v8, s[52:55], s91 offen lds
    s_add_u32 m0, s89, 58368
    s_nop 0
    buffer_load_dwordx4 v9, s[52:55], s91 offen lds
    s_add_u32 m0, s89, 59392
    s_nop 0
    buffer_load_dwordx4 v10, s[52:55], s91 offen lds
    s_cmp_eq_u32 s33, 3
    s_cselect_b64 exec, 1, -1
    buffer_load_dword v27, v26, s[44:47], 0 offen
    s_mov_b64 exec, -1
    s_waitcnt vmcnt(16)
    s_barrier
    s_waitcnt vmcnt(9)
    s_waitcnt vmcnt(5)
    s_barrier
    s_waitcnt vmcnt(4)
    s_mov_b32 s41, 400000
Lwfp_4:
    v_cmp_ne_u32 vcc, s35, v25
    s_nop 4
    s_cbranch_vccnz Lwfok_3_c
Lwfok_3:
    buffer_load_dwordx4 v[80:83], v0, s[44:47], s92 offen offset:0
    buffer_load_dwordx4 v[84:87], v0, s[44:47], s92 offen offset:1024
    buffer_load_dwordx4 v[88:91], v0, s[44:47], s92 offen offset:2048
    buffer_load_dwordx4 v[92:95], v0, s[44:47], s92 offen offset:3072
    s_add_u32 s92, s92, 4096
    buffer_load_dwordx4 v[96:99], v0, s[44:47], s92 offen offset:0
    buffer_load_dwordx4 v[100:103], v0, s[44:47], s92 offen offset:1024
    buffer_load_dwordx4 v[104:107], v0, s[44:47], s92 offen offset:2048
    s_waitcnt vmcnt(8)
    s_barrier
    buffer_load_dwordx4 v[108:111], v0, s[44:47], s92 offen offset:3072
    s_add_u32 s92, s92, 4096
    buffer_load_dwordx4 v[112:115], v0, s[44:47], s92 offen offset:0
    buffer_load_dwordx4 v[116:119], v0, s[44:47], s92 offen offset:1024
    buffer_load_dwordx4 v[120:123], v0, s[44:47], s92 offen offset:2048
    buffer_load_dwordx4 v[124:127], v0, s[44:47], s92 offen offset:3072
    s_add_u32 s92, s92, 4096
    buffer_load_dwordx4 v[128:131], v0, s[44:47], s92 offen offset:0
    buffer_load_dwordx4 v[132:135], v0, s[44:47], s92 offen offset:1024
    s_barrier
    buffer_load_dwordx4 v[136:139], v0, s[44:47], s92 offen offset:2048
    buffer_load_dwordx4 v[140:143], v0, s[44:47], s92 offen offset:3072
    s_add_u32 s92, s92, 4096
    buffer_load_dwordx4 v[144:147], v0, s[44:47], s92 offen offset:0
    buffer_load_dwordx4 v[148:151], v0, s[44:47], s92 offen offset:1024
    buffer_load_dwordx4 v[152:155], v0, s[44:47], s92 offen offset:2048
    buffer_load_dwordx4 v[156:159], v0, s[44:47], s92 offen offset:3072
    s_add_u32 s92, s92, 4096
    buffer_load_dwordx4 v[160:163], v0, s[44:47], s92 offen offset:0
    buffer_load_dwordx4 v[164:167], v0, s[44:47], s92 offen offset:1024
    buffer_load_dwordx4 v[168:171], v0, s[44:47], s92 offen offset:2048
    buffer_load_dwordx4 v[172:175], v0, s[44:47], s92 offen offset:3072
    s_add_u32 s92, s92, 4096
    buffer_load_dwordx4 v[176:179], v0, s[44:47], s92 offen offset:0
    buffer_load_dwordx4 v[180:183], v0, s[44:47], s92 offen offset:1024
    buffer_load_dwordx4 v[184:187], v0, s[44:47], s92 offen offset:2048
    buffer_load_dwordx4 v[188:191], v0, s[44:47], s92 offen offset:3072
    s_add_u32 s92, s92, 4096
    buffer_load_dwordx4 v[192:195], v0, s[44:47], s92 offen offset:0
    buffer_load_dwordx4 v[196:199], v0, s[44:47], s92 offen offset:1024
    buffer_load_dwordx4 v[200:203], v0, s[44:47], s92 offen offset:2048
    buffer_load_dwordx4 v[204:207], v0, s[44:47], s92 offen offset:3072
    s_add_u32 s92, s92, 4096
    buffer_load_dwordx4 v[208:211], v0, s[44:47], s92 offen offset:0
    buffer_load_dwordx4 v[212:215], v0, s[44:47], s92 offen offset:1024
    buffer_load_dwordx4 v[216:219], v0, s[44:47], s92 offen offset:2048
    buffer_load_dwordx4 v[220:223], v0, s[44:47], s92 offen offset:3072
    s_add_u32 s92, s92, 4096
    buffer_load_dwordx4 v[224:227], v0, s[44:47], s92 offen offset:0
    buffer_load_dwordx4 v[228:231], v0, s[44:47], s92 offen offset:1024
    buffer_load_dwordx4 v[232:235], v0, s[44:47], s92 offen offset:2048
    buffer_load_dwordx4 v[236:239], v0, s[44:47], s92 offen offset:3072
    s_add_u32 s92, s92, 4096
    s_cmp_eq_u32 s33, 3
    s_cbranch_scc1 L_MZ
    buffer_load_dwordx4 v[240:243], v0, s[44:47], s92 offen offset:0
    buffer_load_dwordx4 v[244:247], v0, s[44:47], s92 offen offset:1024
    buffer_load_dwordx4 v[248:251], v0, s[44:47], s92 offen offset:2048
    buffer_load_dwordx4 v[252:255], v0, s[44:47], s92 offen offset:3072
L_MW:
    s_mov_b32 s41, 400000
Lhp_5:
    s_mov_b32 exec_lo, s95
    s_mov_b32 exec_hi, 0
    buffer_load_dwordx4 v[12:15], v3, s[44:47], 0 offen sc1
    s_waitcnt vmcnt(0)
    v_xor_b32 v12, s35, v12
    v_xor_b32 v13, s35, v13
    v_xor_b32 v14, s35, v14
    v_xor_b32 v15, s35, v15
    v_or_b32 v12, v12, v13
    v_or3_b32 v12, v12, v14, v15
    v_cmp_ne_u32 vcc, 0, v12
    s_mov_b64 exec, -1
    s_sub_u32 s41, s41, 1
    s_nop 2
    s_cselect_b32 s95, 0, vcc_lo
    s_and_b32 s40, s95, 2063
    s_cbranch_scc1 Lhp_5
    s_add_u32 m0, s94, 0
    s_nop 0
    buffer_load_dwordx4 v0, s[44:47], s93 offen offset:0 lds
    buffer_load_dwordx4 v0, s[44:47], s93 offen offset:1024 lds
    buffer_load_dwordx4 v0, s[44:47], s93 offen offset:2048 lds
    buffer_load_dwordx4 v0, s[44:47], s93 offen offset:3072 lds
    s_add_u32 m0, s94, 4096
    s_add_u32 s93, s93, 4096
    buffer_load_dwordx4 v0, s[44:47], s93 offen offset:0 lds
    buffer_load_dwordx4 v0, s[44:47], s93 offen offset:1024 lds
    buffer_load_dwordx4 v0, s[44:47], s93 offen offset:2048 lds
    buffer_load_dwordx4 v0, s[44:47], s93 offen offset:3072 lds
    s_add_u32 m0, s94, 8192
    s_add_u32 s93, s93, 4096
    buffer_load_dwordx4 v0, s[44:47], s93 offen offset:0 lds
    buffer_load_dwordx4 v0, s[44:47], s93 offen offset:1024 lds
    buffer_load_dwordx4 v0, s[44:47], s93 offen offset:2048 lds
    buffer_load_dwordx4 v0, s[44:47], s93 offen offset:3072 lds
    s_add_u32 m0, s94, 12288
    s_add_u32 s93, s93, 4096
    buffer_load_dwordx4 v0, s[44:47], s93 offen offset:0 lds
    buffer_load_dwordx4 v0, s[44:47], s93 offen offset:1024 lds
    buffer_load_dwordx4 v0, s[44:47], s93 offen offset:2048 lds
    buffer_load_dwordx4 v0, s[44:47], s93 offen offset:3072 lds
    s_setprio 2
    s_waitcnt vmcnt(15)
    ds_read_b128 v[4:7], v2 offset:0
    s_waitcnt vmcnt(14)
    ds_read_b128 v[8:11], v2 offset:1024
    s_waitcnt lgkmcnt(1)
    v_mfma_f32_32x32x16_bf16 v[16:31], v[80:83], v[4:7], 0
    v_mfma_f32_32x32x16_bf16 v[32:47], v[84:87], v[4:7], 0
    s_waitcnt vmcnt(13)
    ds_read_b128 v[12:15], v2 offset:2048
    s_waitcnt lgkmcnt(1)
    v_mfma_f32_32x32x16_bf16 v[48:63], v[80:83], v[8:11], 0
    v_mfma_f32_32x32x16_bf16 v[64:79], v[84:87], v[8:11], 0
    s_waitcnt vmcnt(12)
    ds_read_b128 v[4:7], v2 offset:3072
    s_or_b32 exec_lo, s95, 1
    s_mov_b32 exec_hi, 0
    buffer_load_dwordx4 v[80:83], v3, s[44:47], 0 offen sc1
    s_mov_b64 exec, -1
    s_waitcnt lgkmcnt(1)
    v_mfma_f32_32x32x16_bf16 v[16:31], v[88:91], v[12:15], v[16:31]
    v_mfma_f32_32x32x16_bf16 v[32:47], v[92:95], v[12:15], v[32:47]
    s_waitcnt vmcnt(12)
    ds_read_b128 v[8:11], v2 offset:4096
    s_waitcnt lgkmcnt(1)
    v_mfma_f32_32x32x16_bf16 v[48:63], v[88:91], v[4:7], v[48:63]
    v_mfma_f32_32x32x16_bf16 v[64:79], v[92:95], v[4:7], v[64:79]
    s_waitcnt vmcnt(11)
    ds_read_b128 v[12:15], v2 offset:5120
    s_waitcnt lgkmcnt(1)
    v_mfma_f32_32x32x16_bf16 v[16:31], v[96:99], v[8:11], v[16:31]
    v_mfma_f32_32x32x16_bf16 v[32:47], v[100:103], v[8:11], v[32:47]
    s_waitcnt vmcnt(10)
    ds_read_b128 v[4:7], v2 offset:6144
    s_waitcnt lgkmcnt(1)
    v_mfma_f32_32x32x16_bf16 v[48:63], v[96:99], v[12:15], v[48:63]
    v_mfma_f32_32x32x16_bf16 v[64:79], v[100:103], v[12:15], v[64:79]
    s_waitcnt vmcnt(9)
    ds_read_b128 v[8:11], v2 offset:7168
    s_waitcnt lgkmcnt(1)
    v_mfma_f32_32x32x16_bf16 v[16:31], v[104:107], v[4:7], v[16:31]
    v_mfma_f32_32x32x16_bf16 v[32:47], v[108:111], v[4:7], v[32:47]
    s_waitcnt vmcnt(8)
    ds_read_b128 v[12:15], v2 offset:8192
    s_waitcnt lgkmcnt(1)
    v_mfma_f32_32x32x16_bf16 v[48:63], v[104:107], v[8:11], v[48:63]
    v_mfma_f32_32x32x16_bf16 v[64:79], v[108:111], v[8:11], v[64:79]
    s_waitcnt vmcnt(7)
    ds_read_b128 v[4:7], v2 offset:9216
    s_waitcnt vmcnt(0)
    v_xor_b32 v80, s35, v80
    v_xor_b32 v81, s35, v81
    v_xor_b32 v82, s35, v82
    v_xor_b32 v83, s35, v83
    v_or_b32 v80, v80, v81
    v_or3_b32 v80, v80, v82, v83
    v_cmp_ne_u32 vcc, 0, v80
    s_nop 4
    s_and_b32 s95, s95, vcc_lo
    s_and_b32 s40, s95, 240
    s_cbranch_scc1 Lc_7
    s_add_u32 m0, s94, 16384
    s_add_u32 s93, s93, 4096
    buffer_load_dwordx4 v0, s[44:47], s93 offen offset:0 lds
    buffer_load_dwordx4 v0, s[44:47], s93 offen offset:1024 lds
    buffer_load_dwordx4 v0, s[44:47], s93 offen offset:2048 lds
    s_waitcnt lgkmcnt(1)
    v_mfma_f32_32x32x16_bf16 v[16:31], v[112:115], v[12:15], v[16:31]
    v_mfma_f32_32x32x16_bf16 v[32:47], v[116:119], v[12:15], v[32:47]
    ds_read_b128 v[8:11], v2 offset:10240
    buffer_load_dwordx4 v0, s[44:47], s93 offen offset:3072 lds
    s_add_u32 m0, s94, 20480
    s_add_u32 s93, s93, 4096
    buffer_load_dwordx4 v0, s[44:47], s93 offen offset:0 lds
    buffer_load_dwordx4 v0, s[44:47], s93 offen offset:1024 lds
    s_waitcnt lgkmcnt(1)
    v_mfma_f32_32x32x16_bf16 v[48:63], v[112:115], v[4:7], v[48:63]
    v_mfma_f32_32x32x16_bf16 v[64:79], v[116:119], v[4:7], v[64:79]
    ds_read_b128 v[12:15], v2 offset:11264
    buffer_load_dwordx4 v0, s[44:47], s93 offen offset:2048 lds
    buffer_load_dwordx4 v0, s[44:47], s93 offen offset:3072 lds
    s_add_u32 m0, s94, 24576
    s_add_u32 s93, s93, 4096
    buffer_load_dwordx4 v0, s[44:47], s93 offen offset:0 lds
    s_waitcnt lgkmcnt(1)
    v_mfma_f32_32x32x16_bf16 v[16:31], v[120:123], v[8:11], v[16:31]
    v_mfma_f32_32x32x16_bf16 v[32:47], v[124:127], v[8:11], v[32:47]
    ds_read_b128 v[4:7], v2 offset:12288
    s_or_b32 exec_lo, s95, 1
    s_mov_b32 exec_hi, 0
    buffer_load_dwordx4 v[88:91], v3, s[44:47], 0 offen sc1
    s_mov_b64 exec, -1
    buffer_load_dwordx4 v0, s[44:47], s93 offen offset:1024 lds
    buffer_load_dwordx4 v0, s[44:47], s93 offen offset:2048 lds
    s_waitcnt lgkmcnt(1)
    v_mfma_f32_32x32x16_bf16 v[48:63], v[120:123], v[12:15], v[48:63]
    v_mfma_f32_32x32x16_bf16 v[64:79], v[124:127], v[12:15], v[64:79]
    ds_read_b128 v[8:11], v2 offset:13312
    buffer_load_dwordx4 v0, s[44:47], s93 offen offset:3072 lds
    s_add_u32 m0, s94, 28672
    s_add_u32 s93, s93, 4096
    buffer_load_dwordx4 v0, s[44:47], s93 offen offset:0 lds
    buffer_load_dwordx4 v0, s[44:47], s93 offen offset:1024 lds
    s_waitcnt lgkmcnt(1)
    v_mfma_f32_32x32x16_bf16 v[16:31], v[128:131], v[4:7], v[16:31]
    v_mfma_f32_32x32x16_bf16 v[32:47], v[132:135], v[4:7], v[32:47]
    ds_read_b128 v[12:15], v2 offset:14336
    buffer_load_dwordx4 v0, s[44:47], s93 offen offset:2048 lds
    buffer_load_dwordx4 v0, s[44:47], s93 offen offset:3072 lds
    s_waitcnt lgkmcnt(1)
    v_mfma_f32_32x32x16_bf16 v[48:63], v[128:131], v[8:11], v[48:63]
    v_mfma_f32_32x32x16_bf16 v[64:79], v[132:135], v[8:11], v[64:79]
    ds_read_b128 v[4:7], v2 offset:15360
    s_waitcnt lgkmcnt(1)
    v_mfma_f32_32x32x16_bf16 v[16:31], v[136:139], v[12:15], v[16:31]
    v_mfma_f32_32x32x16_bf16 v[32:47], v[140:143], v[12:15], v[32:47]
    s_waitcnt vmcnt(16)
    ds_read_b128 v[8:11], v2 offset:16384
    s_waitcnt lgkmcnt(1)
    v_mfma_f32_32x32x16_bf16 v[48:63], v[136:139], v[4:7], v[48:63]
    v_mfma_f32_32x32x16_bf16 v[64:79], v[140:143], v[4:7], v[64:79]
    s_waitcnt vmcnt(15)
    ds_read_b128 v[12:15], v2 offset:17408
Lj_8:
    s_waitcnt lgkmcnt(1)
    v_mfma_f32_32x32x16_bf16 v[16:31], v[144:147], v[8:11], v[16:31]
    v_mfma_f32_32x32x16_bf16 v[32:47], v[148:151], v[8:11], v[32:47]
    s_waitcnt vmcnt(14)
    ds_read_b128 v[4:7], v2 offset:18432
    s_waitcnt lgkmcnt(1)
    v_mfma_f32_32x32x16_bf16 v[48:63], v[144:147], v[12:15], v[48:63]
    v_mfma_f32_32x32x16_bf16 v[64:79], v[148:151], v[12:15], v[64:79]
    s_waitcnt vmcnt(13)
    ds_read_b128 v[8:11], v2 offset:19456
    s_waitcnt vmcnt(7)
    v_xor_b32 v88, s35, v88
    v_xor_b32 v89, s35, v89
    v_xor_b32 v90, s35, v90
    v_xor_b32 v91, s35, v91
    v_or_b32 v88, v88, v89
    v_or3_b32 v88, v88, v90, v91
    v_cmp_ne_u32 vcc, 0, v88
    s_nop 4
    s_and_b32 s95, s95, vcc_lo
    v_and_b32 v84, 31, v1
    v_lshrrev_b32 v85, 5, v1
    v_and_b32 v86, 7, v1
    v_xor_b32 v85, v85, v86
    v_lshlrev_b32 v80, 8, v84
    v_lshl_add_u32 v80, v85, 4, v80
    v_add_u32 v80, s94, v80
    v_xor_b32 v81, 32, v80
    v_xor_b32 v82, 64, v80
    v_xor_b32 v83, 96, v80
    s_and_b32 s40, s95, 1792
    s_cbranch_scc1 Lc_11
    s_add_u32 m0, s94, 0
    s_add_u32 s93, s93, 4096
    buffer_load_dwordx4 v0, s[44:47], s93 offen offset:0 lds
    s_waitcnt lgkmcnt(1)
    v_mfma_f32_32x32x16_bf16 v[16:31], v[152:155], v[4:7], v[16:31]
    v_mfma_f32_32x32x16_bf16 v[32:47], v[156:159], v[4:7], v[32:47]
    ds_read_b128 v[12:15], v2 offset:20480
    buffer_load_dwordx4 v0, s[44:47], s93 offen offset:1024 lds
    s_waitcnt lgkmcnt(1)
    v_mfma_f32_32x32x16_bf16 v[48:63], v[152:155], v[8:11], v[48:63]
    v_mfma_f32_32x32x16_bf16 v[64:79], v[156:159], v[8:11], v[64:79]
    ds_read_b128 v[4:7], v2 offset:21504
    buffer_load_dwordx4 v0, s[44:47], s93 offen offset:2048 lds
    s_waitcnt lgkmcnt(1)
    v_mfma_f32_32x32x16_bf16 v[16:31], v[160:163], v[12:15], v[16:31]
    v_mfma_f32_32x32x16_bf16 v[32:47], v[164:167], v[12:15], v[32:47]
    ds_read_b128 v[8:11], v2 offset:22528
    buffer_load_dwordx4 v0, s[44:47], s93 offen offset:3072 lds
    s_waitcnt lgkmcnt(1)
    v_mfma_f32_32x32x16_bf16 v[48:63], v[160:163], v[4:7], v[48:63]
    v_mfma_f32_32x32x16_bf16 v[64:79], v[164:167], v[4:7], v[64:79]
    ds_read_b128 v[12:15], v2 offset:23552
    s_add_u32 m0, s94, 4096
    s_add_u32 s93, s93, 4096
    buffer_load_dwordx4 v0, s[44:47], s93 offen offset:0 lds
    s_waitcnt lgkmcnt(1)
    v_mfma_f32_32x32x16_bf16 v[16:31], v[168:171], v[8:11], v[16:31]
    v_mfma_f32_32x32x16_bf16 v[32:47], v[172:175], v[8:11], v[32:47]
    ds_read_b128 v[4:7], v2 offset:24576
    buffer_load_dwordx4 v0, s[44:47], s93 offen offset:1024 lds
    s_waitcnt lgkmcnt(1)
    v_mfma_f32_32x32x16_bf16 v[48:63], v[168:171], v[12:15], v[48:63]
    v_mfma_f32_32x32x16_bf16 v[64:79], v[172:175], v[12:15], v[64:79]
    s_waitcnt vmcnt(12)
    ds_read_b128 v[8:11], v2 offset:25600
    buffer_load_dwordx4 v0, s[44:47], s93 offen offset:2048 lds
    s_waitcnt lgkmcnt(1)
    v_mfma_f32_32x32x16_bf16 v[16:31], v[176:179], v[4:7], v[16:31]
    v_mfma_f32_32x32x16_bf16 v[32:47], v[180:183], v[4:7], v[32:47]
    s_waitcnt vmcnt(12)
    ds_read_b128 v[12:15], v2 offset:26624
    buffer_load_dwordx4 v0, s[44:47], s93 offen offset:3072 lds
    s_waitcnt lgkmcnt(1)
    v_mfma_f32_32x32x16_bf16 v[48:63], v[176:179], v[8:11], v[48:63]
    v_mfma_f32_32x32x16_bf16 v[64:79], v[180:183], v[8:11], v[64:79]
    s_waitcnt vmcnt(12)
    ds_read_b128 v[4:7], v2 offset:27648
    s_add_u32 m0, s94, 8192
    s_cmp_lt_u32 s33, 3
    s_cselect_b32 s40, 4096, 0
    s_add_u32 s93, s93, s40
    buffer_load_dwordx4 v0, s[44:47], s93 offen offset:0 lds
    s_waitcnt lgkmcnt(1)
    v_mfma_f32_32x32x16_bf16 v[16:31], v[184:187], v[12:15], v[16:31]
    v_mfma_f32_32x32x16_bf16 v[32:47], v[188:191], v[12:15], v[32:47]
    s_waitcnt vmcnt(12)
    ds_read_b128 v[8:11], v2 offset:28672
    buffer_load_dwordx4 v0, s[44:47], s93 offen offset:1024 lds
    s_waitcnt lgkmcnt(1)
    v_mfma_f32_32x32x16_bf16 v[48:63], v[184:187], v[4:7], v[48:63]
    v_mfma_f32_32x32x16_bf16 v[64:79], v[188:191], v[4:7], v[64:79]
    s_waitcnt vmcnt(12)
    ds_read_b128 v[12:15], v2 offset:29696
    buffer_load_dwordx4 v0, s[44:47], s93 offen offset:2048 lds
    s_waitcnt lgkmcnt(1)
    v_mfma_f32_32x32x16_bf16 v[16:31], v[192:195], v[8:11], v[16:31]
    v_mfma_f32_32x32x16_bf16 v[32:47], v[196:199], v[8:11], v[32:47]
    s_waitcnt vmcnt(12)
    ds_read_b128 v[4:7], v2 offset:30720
    buffer_load_dwordx4 v0, s[44:47], s93 offen offset:3072 lds
    s_waitcnt lgkmcnt(1)
    v_mfma_f32_32x32x16_bf16 v[48:63], v[192:195], v[12:15], v[48:63]
    v_mfma_f32_32x32x16_bf16 v[64:79], v[196:199], v[12:15], v[64:79]
    s_waitcnt vmcnt(12)
    ds_read_b128 v[8:11], v2 offset:31744
    s_waitcnt lgkmcnt(1)
    v_mfma_f32_32x32x16_bf16 v[16:31], v[200:203], v[4:7], v[16:31]
    v_mfma_f32_32x32x16_bf16 v[32:47], v[204:207], v[4:7], v[32:47]
    s_waitcnt vmcnt(11)
    ds_read_b128 v[12:15], v2 offset:0
    s_waitcnt lgkmcnt(1)
    v_mfma_f32_32x32x16_bf16 v[48:63], v[200:203], v[8:11], v[48:63]
    v_mfma_f32_32x32x16_bf16 v[64:79], v[204:207], v[8:11], v[64:79]
    s_waitcnt vmcnt(9)
    ds_read_b128 v[4:7], v2 offset:2048
Lj_12:
    s_setprio 0
    s_waitcnt lgkmcnt(1)
    v_mfma_f32_32x32x16_bf16 v[16:31], v[208:211], v[12:15], v[16:31]
    v_mfma_f32_32x32x16_bf16 v[32:47], v[212:215], v[12:15], v[32:47]
    s_waitcnt vmcnt(7)
    ds_read_b128 v[8:11], v2 offset:4096
    s_waitcnt lgkmcnt(1)
    v_mfma_f32_32x32x16_bf16 v[16:31], v[216:219], v[4:7], v[16:31]
    v_mfma_f32_32x32x16_bf16 v[32:47], v[220:223], v[4:7], v[32:47]
    s_waitcnt vmcnt(5)
    ds_read_b128 v[12:15], v2 offset:6144
    s_waitcnt lgkmcnt(1)
    v_mfma_f32_32x32x16_bf16 v[16:31], v[224:227], v[8:11], v[16:31]
    v_mfma_f32_32x32x16_bf16 v[32:47], v[228:231], v[8:11], v[32:47]
    s_waitcnt vmcnt(3)
    ds_read_b128 v[4:7], v2 offset:8192
    s_waitcnt lgkmcnt(1)
    v_mfma_f32_32x32x16_bf16 v[16:31], v[232:235], v[12:15], v[16:31]
    v_mfma_f32_32x32x16_bf16 v[32:47], v[236:239], v[12:15], v[32:47]
    s_waitcnt vmcnt(1)
    ds_read_b128 v[8:11], v2 offset:10240
    s_waitcnt lgkmcnt(1)
    v_mfma_f32_32x32x16_bf16 v[16:31], v[240:243], v[4:7], v[16:31]
    v_mfma_f32_32x32x16_bf16 v[32:47], v[244:247], v[4:7], v[32:47]
    ds_read_b128 v[12:15], v2 offset:1024
    s_waitcnt lgkmcnt(1)
    v_mfma_f32_32x32x16_bf16 v[16:31], v[248:251], v[8:11], v[16:31]
    v_mfma_f32_32x32x16_bf16 v[32:47], v[252:255], v[8:11], v[32:47]
    ds_read_b128 v[4:7], v2 offset:3072
    s_waitcnt lgkmcnt(1)
    v_mfma_f32_32x32x16_bf16 v[48:63], v[208:211], v[12:15], v[48:63]
    v_mfma_f32_32x32x16_bf16 v[64:79], v[212:215], v[12:15], v[64:79]
    ds_read_b128 v[8:11], v2 offset:5120
    s_waitcnt lgkmcnt(1)
    v_mfma_f32_32x32x16_bf16 v[48:63], v[216:219], v[4:7], v[48:63]
    v_mfma_f32_32x32x16_bf16 v[64:79], v[220:223], v[4:7], v[64:79]
    ds_read_b128 v[12:15], v2 offset:7168
    s_nop 1
    ds_write_b128 v80, v[16:19] offset:16384
    ds_write_b128 v81, v[20:23] offset:16384
    s_waitcnt lgkmcnt(3)
    v_mfma_f32_32x32x16_bf16 v[48:63], v[224:227], v[8:11], v[48:63]
    v_mfma_f32_32x32x16_bf16 v[64:79], v[228:231], v[8:11], v[64:79]
    ds_read_b128 v[4:7], v2 offset:9216
    ds_write_b128 v82, v[24:27] offset:16384
    ds_write_b128 v83, v[28:31] offset:16384
    s_waitcnt lgkmcnt(5)
    v_mfma_f32_32x32x16_bf16 v[48:63], v[232:235], v[12:15], v[48:63]
    v_mfma_f32_32x32x16_bf16 v[64:79], v[236:239], v[12:15], v[64:79]
    s_waitcnt vmcnt(0)
    ds_read_b128 v[8:11], v2 offset:11264
    ds_write_b128 v80, v[32:35] offset:16512
    ds_write_b128 v81, v[36:39] offset:16512
    s_waitcnt lgkmcnt(5)
    v_mfma_f32_32x32x16_bf16 v[48:63], v[240:243], v[4:7], v[48:63]
    v_mfma_f32_32x32x16_bf16 v[64:79], v[244:247], v[4:7], v[64:79]
    ds_write_b128 v82, v[40:43] offset:16512
    ds_write_b128 v83, v[44:47] offset:16512
    s_waitcnt lgkmcnt(4)
    v_mfma_f32_32x32x16_bf16 v[48:63], v[248:251], v[8:11], v[48:63]
    v_mfma_f32_32x32x16_bf16 v[64:79], v[252:255], v[8:11], v[64:79]
    s_nop 7
    s_nop 2
    ds_write_b128 v80, v[48:51] offset:24576
    ds_write_b128 v81, v[52:55] offset:24576
    ds_write_b128 v82, v[56:59] offset:24576
    ds_write_b128 v83, v[60:63] offset:24576
    ds_write_b128 v80, v[64:67] offset:24704
    ds_write_b128 v81, v[68:71] offset:24704
    ds_write_b128 v82, v[72:75] offset:24704
    ds_write_b128 v83, v[76:79] offset:24704
    s_waitcnt lgkmcnt(0)
    s_barrier
    s_endpgm
L_C:
    s_memrealtime s[82:83]
    s_setprio 3
    s_lshl_b32 s34, s33, 13
    s_add_u32 s34, s34, 131072
    s_mov_b32 s6, -1
    s_mov_b32 s7, 0
    s_lshr_b32 s40, s32, 2

    s_lshl4_add_u32 s41, s40, s3
    s_lshr_b32 s40, s33, 1
    s_lshl3_add_u32 s41, s40, s41
    s_and_b32 s40, s32, 3
    s_lshl1_add_u32 s41, s40, s41
    s_sub_u32 s42, 1024, s41
    s_bitcmp1_b32 s33, 0
    s_cselect_b32 s42, s42, s41
    s_cselect_b32 s40, 1, 3
    s_cselect_b32 s43, 1, 0
    s_lshl_b32 s43, s43, 9
    s_cmp_eq_u32 s41, 0
    s_cselect_b32 s42, s43, s42
    s_cselect_b32 s40, s40, 2
    s_lshl_b32 s40, s40, 19
    s_lshl_b32 s84, s42, 10
    v_lshrrev_b32 v204, 5, v1
    v_and_b32 v205, 31, v1
    v_mul_lo_u32 v206, v204, s40
    v_lshl_add_u32 v206, v205, 4, v206
    v_lshlrev_b32 v14, 4, v1
    s_mul_i32 s40, s2, 3
    s_add_u32 s40, s40, s33
    s_cmp_lt_u32 s33, 3
    s_cselect_b32 s40, s40, 1000
    s_cmp_lt_u32 s40, 688
    s_cselect_b64 s[10:11], -1, 0
    s_cselect_b32 s40, s40, 0
    s_lshr_b32 s41, s40, 3
    s_and_b32 s40, s40, 7
    s_lshr_b32 s85, s41, 1
    s_mul_i32 s86, s85, 373
    s_lshr_b32 s86, s86, 12
    s_mul_i32 s87, s86, 11
    s_sub_u32 s85, s85, s87
    s_and_b32 s87, s85, 3
    s_lshl2_add_u32 s87, s86, s87
    s_mul_i32 s42, s87, 3
    s_lshl1_add_u32 s87, s87, 11
    s_min_u32 s42, s42, s87
    s_lshr_b32 s87, s85, 2
    s_add_u32 s42, s42, s87
    s_mul_i32 s86, s86, 3
    s_add_u32 s86, s86, s85
    s_mul_i32 s86, s86, 3
    s_sub_u32 s86, s86, 22
    s_cmp_lt_u32 s85, 8
    s_cselect_b32 s42, s42, s86
    s_and_b32 s85, s41, 1
    s_lshl1_add_u32 s42, s42, s85
    s_lshl_b32 s85, s42, 14
    s_lshl_b32 s42, s40, 7
    s_add_u32 s85, s85, s42
    v_lshrrev_b32 v207, 3, v1
    v_lshlrev_b32 v207, 10, v207
    v_and_b32 v208, 7, v1
    v_lshl_add_u32 v207, v208, 4, v207
    s_waitcnt lgkmcnt(0)
    s_mov_b32 s56, s26
    s_and_b32 s57, s27, 0xffff
    s_mov_b32 s58, 256
    s_mov_b32 s59, 0x20000
    s_or_b32 s42, s2, s33
    s_cmp_lg_u32 s42, 0
    s_cbranch_scc1 L_NOTAG

    s_lshl_b32 s42, s82, 2
    s_or_b32 s42, s42, 3
    v_mov_b32 v208, s42
    s_mov_b64 exec, 1
    buffer_store_dword v208, off, s[56:59], 0 sc0 sc1
    s_mov_b64 exec, -1
L_NOTAG:
    s_mov_b32 s48, s4
    s_and_b32 s49, s5, 0xffff
    s_mov_b32 s50, 2097152
    s_mov_b32 s51, 0x20000
    buffer_load_dwordx4 v[136:139], v206, s[48:51], s84 offen
    buffer_load_dwordx4 v[140:143], v206, s[48:51], s84 offen offset:512
    s_mov_b32 s60, s20
    s_and_b32 s61, s21, 0xffff
    s_mov_b32 s62, 1409024
    s_mov_b32 s63, 0x20000
    s_mov_b32 m0, s34
    s_add_u32 s86, s85, 7168
    buffer_load_dwordx4 v207, s[60:63], s85 offen lds
    buffer_load_dwordx4 v207, s[60:63], s86 offen offset:1024 lds
    s_mov_b32 s64, s18
    s_and_b32 s65, s19, 0xffff
    s_mov_b32 s66, 2752
    s_mov_b32 s67, 0x20000
    v_lshlrev_b32 v206, 2, v1
    s_lshl_b32 s42, s36, 6
    buffer_load_dword v156, v206, s[64:67], s42 offen
    s_mov_b32 s44, s28
    s_and_b32 s45, s29, 0xffff
    s_mov_b32 s46, 268435456
    s_mov_b32 s47, 0x20000
    s_mul_i32 s3, s40, 96
    s_add_u32 s3, s3, s41
    s_lshl_b32 s3, s3, 2
    s_add_u32 s3, s3, 32768
    s_lshl_b32 s42, s40, 1
    s_sub_u32 s43, 15, s42
    s_cmp_lt_u32 s40, 4
    s_cselect_b32 s42, s42, s43
    s_lshr_b32 s40, s40, 2
    s_lshl1_add_u32 s41, s41, s40
    s_lshl_b32 s41, s41, 10
    s_add_u32 s41, s41, 10485760
    s_mul_i32 s40, s42, 176128
    s_add_u32 s0, s41, s40
    s_xor_b32 s42, s42, 1
    s_mul_i32 s40, s42, 176128
    s_add_u32 s1, s41, s40
    s_getreg_b32 s37, hwreg(HW_REG_XCC_ID)
    s_lshl4_add_u32 s40, s31, s32
    s_lshl2_add_u32 s40, s40, s33
    s_lshl_b32 s99, s40, 6
    s_lshl_b32 s40, s39, 5
    v_add_u32 v206, s40, v205
    s_cmp_eq_u32 s32, 8
    s_cselect_b32 s41, 0, 99
    v_cmp_eq_u32 vcc, s41, v205
    s_lshl_b32 s42, s38, 7
    v_mov_b32 v207, 256
    v_mov_b32 v212, s42
    v_cndmask_b32 v206, v206, v207, vcc
    v_cndmask_b32 v212, v212, 0, vcc
    s_mov_b64 s[8:9], vcc
    s_lshl_b32 s40, s33, 6
    v_lshl_add_u32 v207, v204, 5, s40
    v_mad_u32_u24 v207, v207, v206, v212
    v_and_b32 v207, 511, v207
    v_cvt_f32_u32 v208, v207
    v_cvt_f32_u32 v210, v206
    v_mul_f32 v208, 0x3b000000, v208
    v_mul_f32 v210, 0x3b000000, v210
    v_lshlrev_b32 v15, 31, v206
    v_cos_f32 v214, v210
    v_mul_f32 v212, 0x41800000, v210
    v_fma_f32 v209, 0.5, v212, v208
    v_add_f32 v214, v214, v214
    v_bfe_u32 v206, v1, 1, 3
    v_lshlrev_b32 v207, 2, v204
    v_xor_b32 v206, v206, v207
    v_lshlrev_b32 v207, 7, v205
    v_lshl_add_u32 v207, v206, 4, v207
    s_lshl_b32 s40, s33, 12
    s_add_u32 s41, s40, 114688
    v_add_u32 v207, s41, v207
    v_pk_add_f32 v[114:115], v[208:209], v[210:211] op_sel_hi:[1,0]
    v_cos_f32 v112, v208
    v_cos_f32 v113, v209
    v_cos_f32 v114, v114
    v_cos_f32 v115, v115
    v_pk_add_f32 v[208:209], v[208:209], v[212:213] op_sel_hi:[1,0]
    v_pk_fma_f32 v[116:117], v[114:115], v[214:215], v[112:113] op_sel_hi:[1,0,1] neg_lo:[0,0,1] neg_hi:[0,0,1]
    v_pk_fma_f32 v[118:119], v[116:117], v[214:215], v[114:115] op_sel_hi:[1,0,1] neg_lo:[0,0,1] neg_hi:[0,0,1]
    v_cvt_pk_bf16_f32 v96, v112, v114
    v_cvt_pk_bf16_f32 v100, v113, v115
    v_pk_fma_f32 v[120:121], v[118:119], v[214:215], v[116:117] op_sel_hi:[1,0,1] neg_lo:[0,0,1] neg_hi:[0,0,1]
    v_pk_fma_f32 v[122:123], v[120:121], v[214:215], v[118:119] op_sel_hi:[1,0,1] neg_lo:[0,0,1] neg_hi:[0,0,1]
    v_cvt_pk_bf16_f32 v97, v116, v118
    v_cvt_pk_bf16_f32 v101, v117, v119
    v_pk_fma_f32 v[124:125], v[122:123], v[214:215], v[120:121] op_sel_hi:[1,0,1] neg_lo:[0,0,1] neg_hi:[0,0,1]
    v_pk_fma_f32 v[126:127], v[124:125], v[214:215], v[122:123] op_sel_hi:[1,0,1] neg_lo:[0,0,1] neg_hi:[0,0,1]
    v_cvt_pk_bf16_f32 v98, v120, v122
    v_cvt_pk_bf16_f32 v102, v121, v123
    v_cvt_pk_bf16_f32 v99, v124, v126
    ds_write_b128 v207, v[96:99]
    v_cvt_pk_bf16_f32 v103, v125, v127
    v_xor_b32 v206, 16, v207
    ds_write_b128 v206, v[100:103]
    v_pk_add_f32 v[114:115], v[208:209], v[210:211] op_sel_hi:[1,0]
    v_cos_f32 v112, v208
    v_cos_f32 v113, v209
    v_cos_f32 v114, v114
    v_cos_f32 v115, v115
    s_nop 0
    v_pk_fma_f32 v[116:117], v[114:115], v[214:215], v[112:113] op_sel_hi:[1,0,1] neg_lo:[0,0,1] neg_hi:[0,0,1]
    v_pk_fma_f32 v[118:119], v[116:117], v[214:215], v[114:115] op_sel_hi:[1,0,1] neg_lo:[0,0,1] neg_hi:[0,0,1]
    v_cvt_pk_bf16_f32 v104, v112, v114
    v_cvt_pk_bf16_f32 v108, v113, v115
    v_pk_fma_f32 v[120:121], v[118:119], v[214:215], v[116:117] op_sel_hi:[1,0,1] neg_lo:[0,0,1] neg_hi:[0,0,1]
    v_pk_fma_f32 v[122:123], v[120:121], v[214:215], v[118:119] op_sel_hi:[1,0,1] neg_lo:[0,0,1] neg_hi:[0,0,1]
    v_cvt_pk_bf16_f32 v105, v116, v118
    v_cvt_pk_bf16_f32 v109, v117, v119
    v_pk_fma_f32 v[124:125], v[122:123], v[214:215], v[120:121] op_sel_hi:[1,0,1] neg_lo:[0,0,1] neg_hi:[0,0,1]
    v_pk_fma_f32 v[126:127], v[124:125], v[214:215], v[122:123] op_sel_hi:[1,0,1] neg_lo:[0,0,1] neg_hi:[0,0,1]
    v_cvt_pk_bf16_f32 v106, v120, v122
    v_cvt_pk_bf16_f32 v110, v121, v123
    v_cvt_pk_bf16_f32 v107, v124, v126
    v_xor_b32 v206, 32, v207
    ds_write_b128 v206, v[104:107]
    v_cvt_pk_bf16_f32 v111, v125, v127
    v_xor_b32 v206, 48, v207
    ds_write_b128 v206, v[108:111]
    v_bfe_u32 v206, v1, 1, 3
    v_xor_b32 v206, v206, v204
    v_lshlrev_b32 v207, 7, v205
    v_lshl_add_u32 v207, v206, 4, v207
    s_lshl_b32 s41, s33, 5
    v_xor_b32 v207, s41, v207
    v_add_u32 v2, s40, v207
    v_add_u32 v10, 114688, v207
    v_xor_b32 v3, 32, v2
    v_xor_b32 v11, 32, v10
    v_xor_b32 v4, 64, v2
    v_xor_b32 v12, 64, v10
    v_xor_b32 v5, 96, v2
    v_xor_b32 v13, 96, v10
    v_lshlrev_b32 v206, 3, v204
    v_bfe_u32 v207, v1, 2, 2
    v_add_u32 v206, v206, v207
    v_bfe_u32 v207, v1, 4, 1
    v_and_b32 v208, 3, v1
    v_lshlrev_b32 v209, 5, v207
    v_lshl_add_u32 v209, v208, 3, v209
    v_mul_u32_u24 v210, 192, v206
    v_add_u32 v210, v210, v209
    v_lshl_add_u32 v211, v206, 7, v209
    v_add_u32 v211, s34, v211
    s_xor_b32 s40, s33, 0
    s_mul_i32 s40, s40, 3072
    s_add_u32 s40, s40, 16384
    v_add_u32 v6, s40, v210
    s_xor_b32 s40, s33, 1
    s_mul_i32 s40, s40, 3072
    s_add_u32 s40, s40, 16384
    v_add_u32 v7, s40, v210
    s_xor_b32 s40, s33, 2
    s_mul_i32 s40, s40, 3072
    s_add_u32 s40, s40, 16384
    v_add_u32 v8, s40, v210
    s_xor_b32 s40, s33, 3
    s_mul_i32 s40, s40, 3072
    s_add_u32 s40, s40, 16384
    v_add_u32 v9, s40, v210
    v_bfe_u32 v209, v1, 2, 1
    v_xor_b32 v209, v209, v207
    v_lshl_or_b32 v209, v209, 2, v208
    v_mov_b32 v210, 0x3f803f80
    v_cmp_eq_u32 vcc, 0, v209
    s_nop 1
    v_cndmask_b32 v16, 0, v210, vcc
    v_mov_b32 v17, v16
    v_mov_b32 v18, v16
    v_mov_b32 v19, v16
    v_cmp_eq_u32 vcc, 1, v209
    s_nop 1
    v_cndmask_b32 v20, 0, v210, vcc
    v_mov_b32 v21, v20
    v_mov_b32 v22, v20
    v_mov_b32 v23, v20
    v_cmp_eq_u32 vcc, 2, v209
    s_nop 1
    v_cndmask_b32 v24, 0, v210, vcc
    v_mov_b32 v25, v24
    v_mov_b32 v26, v24
    v_mov_b32 v27, v24
    v_mov_b32 v255, 0
    v_mov_b32 v209, 163584
    ds_write_b32 v209, v255 offset:4
    buffer_load_dword v252, off, s[56:59], 0 sc0 sc1
    s_waitcnt vmcnt(2)
    ds_read_b64_tr_b16 v[212:213], v211 offset:0
    ds_read_b64_tr_b16 v[214:215], v211 offset:512
    ds_read_b64_tr_b16 v[216:217], v211 offset:64
    ds_read_b64_tr_b16 v[218:219], v211 offset:576
    v_lshlrev_b32 v96, 16, v136
    v_and_b32 v97, 0xffff0000, v136
    v_lshlrev_b32 v98, 16, v137
    v_and_b32 v99, 0xffff0000, v137
    v_lshlrev_b32 v100, 16, v138
    v_and_b32 v101, 0xffff0000, v138
    v_lshlrev_b32 v102, 16, v139
    v_and_b32 v103, 0xffff0000, v139
    v_lshlrev_b32 v104, 16, v140
    v_and_b32 v105, 0xffff0000, v140
    v_lshlrev_b32 v106, 16, v141
    v_and_b32 v107, 0xffff0000, v141
    v_lshlrev_b32 v108, 16, v142
    v_and_b32 v109, 0xffff0000, v142
    v_lshlrev_b32 v110, 16, v143
    v_and_b32 v111, 0xffff0000, v143
    v_readlane_b32 s40, v96, 0
    v_readlane_b32 s41, v96, 32
    s_waitcnt lgkmcnt(0)
    s_mov_b64 exec, s[10:11]
    buffer_store_dwordx4 v[212:215], v14, s[44:47], s0 offen sc1
    buffer_store_dwordx4 v[216:219], v14, s[44:47], s1 offen sc1
    s_mov_b64 exec, -1
    v_mov_b32 v206, s41
    v_mov_b32 v207, s40
    v_cndmask_b32 v206, v206, v207, s[6:7]
    v_pk_add_f32 v[96:97], v[96:97], v[206:207] op_sel_hi:[1,0] neg_lo:[0,1] neg_hi:[0,1]
    v_pk_add_f32 v[98:99], v[98:99], v[206:207] op_sel_hi:[1,0] neg_lo:[0,1] neg_hi:[0,1]
    v_pk_add_f32 v[100:101], v[100:101], v[206:207] op_sel_hi:[1,0] neg_lo:[0,1] neg_hi:[0,1]
    v_pk_add_f32 v[102:103], v[102:103], v[206:207] op_sel_hi:[1,0] neg_lo:[0,1] neg_hi:[0,1]
    v_pk_add_f32 v[104:105], v[104:105], v[206:207] op_sel_hi:[1,0] neg_lo:[0,1] neg_hi:[0,1]
    v_pk_add_f32 v[106:107], v[106:107], v[206:207] op_sel_hi:[1,0] neg_lo:[0,1] neg_hi:[0,1]
    v_pk_add_f32 v[108:109], v[108:109], v[206:207] op_sel_hi:[1,0] neg_lo:[0,1] neg_hi:[0,1]
    v_pk_add_f32 v[110:111], v[110:111], v[206:207] op_sel_hi:[1,0] neg_lo:[0,1] neg_hi:[0,1]
    v_pk_add_f32 v[208:209], v[96:97], v[98:99]
    v_pk_mul_f32 v[210:211], v[96:97], v[96:97]
    v_pk_fma_f32 v[210:211], v[98:99], v[98:99], v[210:211]
    v_pk_add_f32 v[208:209], v[208:209], v[100:101]
    v_pk_fma_f32 v[210:211], v[100:101], v[100:101], v[210:211]
    v_pk_add_f32 v[208:209], v[208:209], v[102:103]
    v_pk_fma_f32 v[210:211], v[102:103], v[102:103], v[210:211]
    v_pk_add_f32 v[208:209], v[208:209], v[104:105]
    v_pk_fma_f32 v[210:211], v[104:105], v[104:105], v[210:211]
    v_pk_add_f32 v[208:209], v[208:209], v[106:107]
    v_pk_fma_f32 v[210:211], v[106:107], v[106:107], v[210:211]
    v_pk_add_f32 v[208:209], v[208:209], v[108:109]
    v_pk_fma_f32 v[210:211], v[108:109], v[108:109], v[210:211]
    v_pk_add_f32 v[208:209], v[208:209], v[110:111]
    v_pk_fma_f32 v[210:211], v[110:111], v[110:111], v[210:211]
    v_add_f32 v208, v208, v209
    v_add_f32 v210, v210, v211
    s_nop 0
    v_add_f32_dpp v209, v208, v208 quad_perm:[1,0,3,2] row_mask:0xf bank_mask:0xf
    v_add_f32_dpp v211, v210, v210 quad_perm:[1,0,3,2] row_mask:0xf bank_mask:0xf
    s_nop 0
    v_add_f32_dpp v208, v209, v209 quad_perm:[2,3,0,1] row_mask:0xf bank_mask:0xf
    v_add_f32_dpp v210, v211, v211 quad_perm:[2,3,0,1] row_mask:0xf bank_mask:0xf
    s_nop 0
    v_add_f32_dpp v209, v208, v208 row_half_mirror row_mask:0xf bank_mask:0xf
    v_add_f32_dpp v211, v210, v210 row_half_mirror row_mask:0xf bank_mask:0xf
    s_nop 0
    v_add_f32_dpp v208, v209, v209 row_mirror row_mask:0xf bank_mask:0xf
    v_add_f32_dpp v210, v211, v211 row_mirror row_mask:0xf bank_mask:0xf
    v_mov_b32 v209, v208
    v_mov_b32 v211, v210
    s_nop 0
    v_permlane16_swap_b32 v208, v209
    v_permlane16_swap_b32 v210, v211
    s_nop 0
    v_add_f32 v208, v208, v209
    v_add_f32 v210, v210, v211
    v_mul_f32 v96, 0x3b000000, v208
    v_mul_f32 v97, 0x3b000000, v210
    v_fma_f32 v97, -v96, v96, v97
    v_max_f32 v97, 0, v97
    v_add_f32 v98, v206, v96
    v_cvt_pk_bf16_f32 v101, v98, v97
    v_lshlrev_b32 v99, 16, v101
    v_and_b32 v104, 0xffff0000, v101
    v_add_f32 v104, 0x3727c5ac, v104
    v_cvt_pk_bf16_f32 v101, v104, v104
    v_lshlrev_b32 v104, 16, v101
    v_sqrt_f32 v104, v104
    v_sub_f32 v98, v99, v206
    v_cvt_pk_bf16_f32 v101, v104, v104
    v_lshlrev_b32 v104, 16, v101
    v_rcp_f32 v100, v104
    v_sub_f32 v98, v96, v98
    v_mul_f32 v102, v98, v100
    v_mul_f32 v104, v97, v100
    v_mul_f32 v104, v104, v100
    v_cvt_pk_bf16_f32 v101, v102, v104
    v_lshlrev_b32 v102, 16, v101
    v_and_b32 v104, 0xffff0000, v101
    v_add_f32 v104, 0x3727c5ac, v104
    v_cvt_pk_bf16_f32 v101, v104, v104
    v_lshlrev_b32 v104, 16, v101
    v_sqrt_f32 v104, v104
    v_mul_f32 v96, v99, v100
    v_cvt_pk_bf16_f32 v101, v104, v104
    v_lshlrev_b32 v104, 16, v101
    v_rcp_f32 v103, v104
    v_add_f32 v102, v96, v102
    v_cmp_eq_u32 vcc, 0, v205
    v_mul_f32 v97, v100, v103
    v_mul_f32 v102, v102, v103
    v_mul_f32 v96, 0xc4000000, v96
    v_cndmask_b32 v244, v97, v100, vcc
    v_cndmask_b32 v246, v102, v96, vcc
    v_writelane_b32 v244, s37, 2
    v_writelane_b32 v246, s37, 2
    buffer_load_dword v253, off, s[56:59], 0 sc0 sc1
    s_waitcnt lgkmcnt(0)
    s_setprio 2
    s_barrier
    ds_read_b128 v[96:99], v2 offset:0
    ds_read_b64_tr_b16 v[100:101], v6 offset:0
    ds_read_b64_tr_b16 v[102:103], v6 offset:768
    ds_read_b64_tr_b16 v[104:105], v6 offset:64
    ds_read_b64_tr_b16 v[106:107], v6 offset:832
    ds_read_b64_tr_b16 v[108:109], v6 offset:128
    ds_read_b64_tr_b16 v[110:111], v6 offset:896
    ds_read_b128 v[112:115], v10 offset:0
    s_waitcnt lgkmcnt(5)
    v_mfma_f32_32x32x16_bf16 v[32:47], v[100:103], v[96:99], 0
    ds_read_b128 v[116:119], v3 offset:0
    ds_read_b64_tr_b16 v[120:121], v7 offset:0
    v_lshrrev_b32 v220, 5, v1
    v_and_b32 v221, 31, v1
    v_lshlrev_b32 v222, 5, v220
    s_waitcnt lgkmcnt(5)
    v_mfma_f32_32x32x16_bf16 v[48:63], v[104:107], v[96:99], 0
    ds_read_b64_tr_b16 v[122:123], v7 offset:768
    ds_read_b64_tr_b16 v[124:125], v7 offset:64
    v_lshl_add_u32 v222, v221, 4, v222
    s_lshl4_add_u32 s84, s31, s32
    s_lshl_b32 s84, s84, 4
    s_waitcnt lgkmcnt(5)
    v_mfma_f32_32x32x16_bf16 v[64:79], v[108:111], v[96:99], 0
    ds_read_b64_tr_b16 v[126:127], v7 offset:832
    ds_read_b64_tr_b16 v[128:129], v7 offset:128
    s_add_u32 s84, s84, 65536
    s_sub_u32 s84, s84, s99
    v_writelane_b32 v222, s84, 2
    s_waitcnt lgkmcnt(6)
    v_mfma_f32_32x32x16_bf16 v[80:95], v[96:99], v[112:115], 0
    ds_read_b64_tr_b16 v[130:131], v7 offset:896
    ds_read_b128 v[132:135], v11 offset:0
    s_add_u32 s99, s99, 262144
    v_mfma_f32_16x16x32_bf16 v[28:31], v[16:19], v[100:103], 0
    v_mfma_f32_16x16x32_bf16 v[28:31], v[20:23], v[104:107], v[28:31]
    v_mfma_f32_16x16x32_bf16 v[28:31], v[24:27], v[108:111], v[28:31]
    s_waitcnt vmcnt(3)
    v_readfirstlane_b32 s35, v252
    v_mov_b32 v223, 163584
    s_add_u32 s40, s99, 0
    s_cmp_eq_u32 s35, 0
    s_cbranch_scc1 Lc_15
Lj_16:
    v_mov_b32 v255, s35
    v_mov_b32 v245, v255
    v_mov_b32 v247, v255
    s_cmp_eq_u32 s33, 0
    s_cselect_b32 exec_lo, 7, 3
    s_mov_b32 exec_hi, 3
    buffer_store_dwordx4 v[244:247], v222, s[44:47], s99 offen sc1
    ds_write_b32 v223, v255
    s_mov_b64 exec, -1
    s_waitcnt lgkmcnt(6)
    v_mfma_f32_32x32x16_bf16 v[32:47], v[120:123], v[116:119], v[32:47]
    ds_read_b128 v[96:99], v4 offset:0
    ds_read_b64_tr_b16 v[100:101], v8 offset:0
    s_waitcnt lgkmcnt(6)
    v_mfma_f32_32x32x16_bf16 v[48:63], v[124:127], v[116:119], v[48:63]
    ds_read_b64_tr_b16 v[102:103], v8 offset:768
    ds_read_b64_tr_b16 v[104:105], v8 offset:64
    s_waitcnt lgkmcnt(6)
    v_mfma_f32_32x32x16_bf16 v[64:79], v[128:131], v[116:119], v[64:79]
    ds_read_b64_tr_b16 v[106:107], v8 offset:832
    ds_read_b64_tr_b16 v[108:109], v8 offset:128
    s_waitcnt lgkmcnt(7)
    v_mfma_f32_32x32x16_bf16 v[80:95], v[116:119], v[132:135], v[80:95]
    ds_read_b64_tr_b16 v[110:111], v8 offset:896
    ds_read_b128 v[112:115], v12 offset:0
    s_waitcnt lgkmcnt(5)
    v_mfma_f32_32x32x16_bf16 v[32:47], v[100:103], v[96:99], v[32:47]
    ds_read_b128 v[116:119], v5 offset:0
    ds_read_b64_tr_b16 v[120:121], v9 offset:0
    s_lshl_b32 s84, s31, 12
    s_lshl_b32 s85, s33, 10
    s_waitcnt lgkmcnt(5)
    v_mfma_f32_32x32x16_bf16 v[48:63], v[104:107], v[96:99], v[48:63]
    ds_read_b64_tr_b16 v[122:123], v9 offset:768
    ds_read_b64_tr_b16 v[124:125], v9 offset:64
    s_add_u32 s84, s84, s85
    s_add_u32 s98, s84, 262144
    s_waitcnt lgkmcnt(5)
    v_mfma_f32_32x32x16_bf16 v[64:79], v[108:111], v[96:99], v[64:79]
    ds_read_b64_tr_b16 v[126:127], v9 offset:832
    ds_read_b64_tr_b16 v[128:129], v9 offset:128
    v_lshlrev_b32 v243, 5, v221
    v_and_b32 v254, 15, v1
    s_waitcnt lgkmcnt(6)
    v_mfma_f32_32x32x16_bf16 v[80:95], v[96:99], v[112:115], v[80:95]
    ds_read_b64_tr_b16 v[130:131], v9 offset:896
    ds_read_b128 v[132:135], v13 offset:0
    v_lshlrev_b32 v254, 4, v254
    s_lshl_b32 s99, s31, 8
    s_barrier
    s_waitcnt lgkmcnt(5)
    v_mfma_f32_32x32x16_bf16 v[32:47], v[120:123], v[116:119], v[32:47]
    ds_read_b128 v[96:99], v2 offset:28672
    ds_read_b64_tr_b16 v[100:101], v6 offset:28672
    s_add_u32 s99, s99, 327680
    s_waitcnt lgkmcnt(5)
    v_mfma_f32_32x32x16_bf16 v[48:63], v[124:127], v[116:119], v[48:63]
    ds_read_b64_tr_b16 v[102:103], v6 offset:29440
    ds_read_b64_tr_b16 v[104:105], v6 offset:28736
    v_lshlrev_b32 v158, 16, v156
    s_waitcnt lgkmcnt(5)
    v_mfma_f32_32x32x16_bf16 v[64:79], v[128:131], v[116:119], v[64:79]
    ds_read_b64_tr_b16 v[106:107], v6 offset:29504
    ds_read_b64_tr_b16 v[108:109], v6 offset:28800
    v_and_b32 v159, 0xffff0000, v156
    v_lshl_add_u32 v160, v1, 3, s34
    s_waitcnt lgkmcnt(6)
    v_mfma_f32_32x32x16_bf16 v[80:95], v[116:119], v[132:135], v[80:95]
    ds_read_b64_tr_b16 v[110:111], v6 offset:29568
    ds_read_b128 v[112:115], v10 offset:4096
    s_add_u32 s84, s34, 4608
    v_lshl_add_u32 v235, v220, 4, s84
    s_and_b64 exec, s[10:11], 1
    s_waitcnt vmcnt(2)
    buffer_store_dword v255, off, s[44:47], s3 sc0 sc1
    s_mov_b64 exec, -1
    s_waitcnt lgkmcnt(5)
    v_mfma_f32_32x32x16_bf16 v[32:47], v[100:103], v[96:99], v[32:47]
    ds_read_b128 v[116:119], v3 offset:28672
    ds_read_b64_tr_b16 v[120:121], v7 offset:28672
    v_bfe_u32 v223, v221, 3, 1
    v_mul_u32_u24 v233, 176128, v223
    s_waitcnt lgkmcnt(5)
    v_mfma_f32_32x32x16_bf16 v[48:63], v[104:107], v[96:99], v[48:63]
    ds_read_b64_tr_b16 v[122:123], v7 offset:29440
    ds_read_b64_tr_b16 v[124:125], v7 offset:28736
    v_and_b32 v223, 1, v221
    v_lshl_add_u32 v233, v223, 10, v233
    s_waitcnt lgkmcnt(5)
    v_mfma_f32_32x32x16_bf16 v[64:79], v[108:111], v[96:99], v[64:79]
    ds_read_b64_tr_b16 v[126:127], v7 offset:29504
    ds_read_b64_tr_b16 v[128:129], v7 offset:28800
    v_lshl_add_u32 v233, v220, 9, v233
    v_bfe_u32 v224, v221, 1, 1
    s_waitcnt lgkmcnt(6)
    v_mfma_f32_32x32x16_bf16 v[80:95], v[96:99], v[112:115], v[80:95]
    ds_read_b64_tr_b16 v[130:131], v7 offset:29568
    ds_read_b128 v[132:135], v11 offset:4096
    v_xor_b32 v223, v223, v224
    v_lshl_add_u32 v233, v223, 4, v233
    v_mfma_f32_16x16x32_bf16 v[28:31], v[16:19], v[100:103], v[28:31]
    v_mfma_f32_16x16x32_bf16 v[28:31], v[20:23], v[104:107], v[28:31]
    v_mfma_f32_16x16x32_bf16 v[28:31], v[24:27], v[108:111], v[28:31]
    s_waitcnt lgkmcnt(5)
    v_mfma_f32_32x32x16_bf16 v[32:47], v[120:123], v[116:119], v[32:47]
    ds_read_b128 v[96:99], v4 offset:28672
    ds_read_b64_tr_b16 v[100:101], v8 offset:28672
    v_bfe_u32 v223, v221, 4, 1
    v_lshl_add_u32 v233, v223, 5, v233
    s_waitcnt lgkmcnt(5)
    v_mfma_f32_32x32x16_bf16 v[48:63], v[124:127], v[116:119], v[48:63]
    ds_read_b64_tr_b16 v[102:103], v8 offset:29440
    ds_read_b64_tr_b16 v[104:105], v8 offset:28736
    v_bfe_u32 v223, v221, 2, 1
    v_lshl_add_u32 v233, v223, 6, v233
    s_waitcnt lgkmcnt(5)
    v_mfma_f32_32x32x16_bf16 v[64:79], v[128:131], v[116:119], v[64:79]
    ds_read_b64_tr_b16 v[106:107], v8 offset:29504
    ds_read_b64_tr_b16 v[108:109], v8 offset:28800
    s_lshr_b32 s84, s32, 2
    s_mul_i32 s84, s84, 11
    s_waitcnt lgkmcnt(6)
    v_mfma_f32_32x32x16_bf16 v[80:95], v[116:119], v[132:135], v[80:95]
    ds_read_b64_tr_b16 v[110:111], v8 offset:29568
    ds_read_b128 v[112:115], v12 offset:4096
    s_and_b32 s85, s32, 3
    s_add_u32 s84, s84, s85
    s_waitcnt lgkmcnt(5)
    v_mfma_f32_32x32x16_bf16 v[32:47], v[100:103], v[96:99], v[32:47]
    ds_read_b128 v[116:119], v5 offset:28672
    ds_read_b64_tr_b16 v[120:121], v9 offset:28672
    s_mul_i32 s85, s32, 11
    s_lshr_b32 s85, s85, 5
    s_waitcnt lgkmcnt(5)
    v_mfma_f32_32x32x16_bf16 v[48:63], v[104:107], v[96:99], v[48:63]
    ds_read_b64_tr_b16 v[122:123], v9 offset:29440
    ds_read_b64_tr_b16 v[124:125], v9 offset:28736
    s_lshl3_add_u32 s85, s85, s32
    s_add_u32 s85, s85, 8
    s_waitcnt lgkmcnt(5)
    v_mfma_f32_32x32x16_bf16 v[64:79], v[108:111], v[96:99], v[64:79]
    ds_read_b64_tr_b16 v[126:127], v9 offset:29504
    ds_read_b64_tr_b16 v[128:129], v9 offset:28800
    s_mul_i32 s86, s31, 352256
    s_lshl_b32 s87, s33, 7
    s_waitcnt lgkmcnt(6)
    v_mfma_f32_32x32x16_bf16 v[80:95], v[96:99], v[112:115], v[80:95]
    ds_read_b64_tr_b16 v[130:131], v9 offset:29568
    ds_read_b128 v[132:135], v13 offset:4096
    s_add_u32 s86, s86, s87
    s_add_u32 s86, s86, 4194304
    s_barrier
    v_add_u32 v2, 57344, v2
    v_add_u32 v3, 57344, v3
    v_add_u32 v4, 57344, v4
    v_add_u32 v5, 57344, v5
    v_add_u32 v6, 57344, v6
    v_add_u32 v7, 57344, v7
    v_add_u32 v8, 57344, v8
    v_add_u32 v9, 57344, v9
    s_waitcnt lgkmcnt(5)
    v_mfma_f32_32x32x16_bf16 v[32:47], v[120:123], v[116:119], v[32:47]
    ds_read_b128 v[96:99], v2 offset:0
    ds_read_b64_tr_b16 v[100:101], v6 offset:0
    s_lshl_b32 s87, s84, 12
    s_add_u32 s88, s86, s87
    s_waitcnt lgkmcnt(5)
    v_mfma_f32_32x32x16_bf16 v[48:63], v[124:127], v[116:119], v[48:63]
    ds_read_b64_tr_b16 v[102:103], v6 offset:768
    ds_read_b64_tr_b16 v[104:105], v6 offset:64
    s_add_u32 s89, s88, 16384
    s_lshl_b32 s87, s85, 12
    s_waitcnt lgkmcnt(5)
    v_mfma_f32_32x32x16_bf16 v[64:79], v[128:131], v[116:119], v[64:79]
    ds_read_b64_tr_b16 v[106:107], v6 offset:832
    ds_read_b64_tr_b16 v[108:109], v6 offset:128
    s_add_u32 s90, s86, s87
    s_mul_i32 s86, s31, 44
    s_waitcnt lgkmcnt(6)
    v_mfma_f32_32x32x16_bf16 v[80:95], v[116:119], v[132:135], v[80:95]
    ds_read_b64_tr_b16 v[110:111], v6 offset:896
    ds_read_b128 v[112:115], v10 offset:8192
    s_add_u32 s84, s84, s86
    s_add_u32 s85, s85, s86
    s_waitcnt lgkmcnt(5)
    v_mfma_f32_32x32x16_bf16 v[32:47], v[100:103], v[96:99], v[32:47]
    ds_read_b128 v[116:119], v3 offset:0
    ds_read_b64_tr_b16 v[120:121], v7 offset:0
    s_lshl2_add_u32 s84, s84, s33
    s_lshl2_add_u32 s85, s85, s33
    s_waitcnt lgkmcnt(5)
    v_mfma_f32_32x32x16_bf16 v[48:63], v[104:107], v[96:99], v[48:63]
    ds_read_b64_tr_b16 v[122:123], v7 offset:768
    ds_read_b64_tr_b16 v[124:125], v7 offset:64
    s_lshl_b32 s91, s84, 2
    s_add_u32 s92, s91, 64
    s_waitcnt lgkmcnt(5)
    v_mfma_f32_32x32x16_bf16 v[64:79], v[108:111], v[96:99], v[64:79]
    ds_read_b64_tr_b16 v[126:127], v7 offset:832
    ds_read_b64_tr_b16 v[128:129], v7 offset:128
    s_lshl_b32 s93, s85, 2
    s_lshl4_add_u32 s84, s32, s31
    s_waitcnt lgkmcnt(6)
    v_mfma_f32_32x32x16_bf16 v[80:95], v[96:99], v[112:115], v[80:95]
    ds_read_b64_tr_b16 v[130:131], v7 offset:896
    ds_read_b128 v[132:135], v11 offset:8192
    s_lshl_b32 s84, s84, 4
    s_lshl2_add_u32 s84, s33, s84
    v_mfma_f32_16x16x32_bf16 v[28:31], v[16:19], v[100:103], v[28:31]
    v_mfma_f32_16x16x32_bf16 v[28:31], v[20:23], v[104:107], v[28:31]
    v_mfma_f32_16x16x32_bf16 v[28:31], v[24:27], v[108:111], v[28:31]
    s_waitcnt lgkmcnt(5)
    v_mfma_f32_32x32x16_bf16 v[32:47], v[120:123], v[116:119], v[32:47]
    ds_read_b128 v[96:99], v4 offset:0
    ds_read_b64_tr_b16 v[100:101], v8 offset:0
    s_add_u32 s94, s84, 65536
    v_mov_b32 v236, 0xc0135761
    s_waitcnt lgkmcnt(5)
    v_mfma_f32_32x32x16_bf16 v[48:63], v[124:127], v[116:119], v[48:63]
    ds_read_b64_tr_b16 v[102:103], v8 offset:768
    ds_read_b64_tr_b16 v[104:105], v8 offset:64
    v_mov_b32 v237, 1.0
    s_mov_b32 s100, 0xbdd2d3e8
    s_waitcnt lgkmcnt(5)
    v_mfma_f32_32x32x16_bf16 v[64:79], v[128:131], v[116:119], v[64:79]
    ds_read_b64_tr_b16 v[106:107], v8 offset:832
    ds_read_b64_tr_b16 v[108:109], v8 offset:128
    s_mul_i32 s84, s38, 270336
    s_lshl_b32 s85, s39, 9
    s_waitcnt lgkmcnt(6)
    v_mfma_f32_32x32x16_bf16 v[80:95], v[116:119], v[132:135], v[80:95]
    ds_read_b64_tr_b16 v[110:111], v8 offset:896
    ds_read_b128 v[112:115], v12 offset:8192
    s_add_u32 s84, s84, s85
    v_lshl_add_u32 v238, v221, 4, s84
    s_waitcnt lgkmcnt(5)
    v_mfma_f32_32x32x16_bf16 v[32:47], v[100:103], v[96:99], v[32:47]
    ds_read_b128 v[116:119], v5 offset:0
    ds_read_b64_tr_b16 v[120:121], v9 offset:0
    s_cmp_ge_u32 s32, 8
    s_cselect_b32 s85, -1.0, 1.0
    s_waitcnt lgkmcnt(5)
    v_mfma_f32_32x32x16_bf16 v[48:63], v[104:107], v[96:99], v[48:63]
    ds_read_b64_tr_b16 v[122:123], v9 offset:768
    ds_read_b64_tr_b16 v[124:125], v9 offset:64
    v_mov_b32 v239, s85
    v_mov_b32 v223, 4096
    s_waitcnt lgkmcnt(5)
    v_mfma_f32_32x32x16_bf16 v[64:79], v[108:111], v[96:99], v[64:79]
    ds_read_b64_tr_b16 v[126:127], v9 offset:832
    ds_read_b64_tr_b16 v[128:129], v9 offset:128
    v_cndmask_b32 v238, v238, v223, s[8:9]
    v_cndmask_b32 v239, v239, 1.0, s[8:9]
    s_waitcnt lgkmcnt(6)
    v_mfma_f32_32x32x16_bf16 v[80:95], v[96:99], v[112:115], v[80:95]
    ds_read_b64_tr_b16 v[130:131], v9 offset:896
    ds_read_b128 v[132:135], v13 offset:8192
    v_xor_b32 v223, 1, v220
    v_mul_u32_u24 v223, 540672, v223
    s_barrier
    s_waitcnt lgkmcnt(5)
    v_mfma_f32_32x32x16_bf16 v[32:47], v[120:123], v[116:119], v[32:47]
    ds_read_b128 v[96:99], v2 offset:28672
    ds_read_b64_tr_b16 v[100:101], v6 offset:28672
    v_add_u32 v238, v238, v223
    s_lshl2_add_u32 s84, s31, s33
    s_waitcnt lgkmcnt(5)
    v_mfma_f32_32x32x16_bf16 v[48:63], v[124:127], v[116:119], v[48:63]
    ds_read_b64_tr_b16 v[102:103], v6 offset:29440
    ds_read_b64_tr_b16 v[104:105], v6 offset:28736
    s_mul_i32 s84, s84, 4224
    s_add_u32 s95, s84, 1048576
    s_waitcnt lgkmcnt(5)
    v_mfma_f32_32x32x16_bf16 v[64:79], v[128:131], v[116:119], v[64:79]
    ds_read_b64_tr_b16 v[106:107], v6 offset:29504
    ds_read_b64_tr_b16 v[108:109], v6 offset:28800
    s_add_u32 s84, s34, 5120
    v_lshl_add_u32 v240, v220, 4, s84
    s_waitcnt lgkmcnt(6)
    v_mfma_f32_32x32x16_bf16 v[80:95], v[116:119], v[132:135], v[80:95]
    ds_read_b64_tr_b16 v[110:111], v6 offset:29568
    ds_read_b128 v[112:115], v10 offset:12288
    v_lshlrev_b32 v242, 4, v221
    v_add_u32 v242, 135168, v242
    s_waitcnt lgkmcnt(5)
    v_mfma_f32_32x32x16_bf16 v[32:47], v[100:103], v[96:99], v[32:47]
    ds_read_b128 v[116:119], v3 offset:28672
    ds_read_b64_tr_b16 v[120:121], v7 offset:28672
    s_cmp_eq_u32 s32, 0
    s_cselect_b32 s84, 0, 99
    s_waitcnt lgkmcnt(5)
    v_mfma_f32_32x32x16_bf16 v[48:63], v[104:107], v[96:99], v[48:63]
    ds_read_b64_tr_b16 v[122:123], v7 offset:29440
    ds_read_b64_tr_b16 v[124:125], v7 offset:28736
    v_cmp_eq_u32 vcc, s84, v221
    v_add_u32 v227, 1536, v240
    s_waitcnt lgkmcnt(5)
    v_mfma_f32_32x32x16_bf16 v[64:79], v[108:111], v[96:99], v[64:79]
    ds_read_b64_tr_b16 v[126:127], v7 offset:29504
    ds_read_b64_tr_b16 v[128:129], v7 offset:28800
    v_add_u32 v223, 128, v240
    v_cndmask_b32 v227, v227, v223, vcc
    s_waitcnt lgkmcnt(6)
    v_mfma_f32_32x32x16_bf16 v[80:95], v[96:99], v[112:115], v[80:95]
    ds_read_b64_tr_b16 v[130:131], v7 offset:29568
    ds_read_b128 v[132:135], v11 offset:12288
    v_mov_b32 v222, 0
    v_mfma_f32_16x16x32_bf16 v[28:31], v[16:19], v[100:103], v[28:31]
    v_mfma_f32_16x16x32_bf16 v[28:31], v[20:23], v[104:107], v[28:31]
    v_mfma_f32_16x16x32_bf16 v[28:31], v[24:27], v[108:111], v[28:31]
    s_waitcnt lgkmcnt(5)
    v_mfma_f32_32x32x16_bf16 v[32:47], v[120:123], v[116:119], v[32:47]
    ds_read_b128 v[96:99], v4 offset:28672
    ds_read_b64_tr_b16 v[100:101], v8 offset:28672
    s_waitcnt lgkmcnt(5)
    v_mfma_f32_32x32x16_bf16 v[48:63], v[124:127], v[116:119], v[48:63]
    ds_read_b64_tr_b16 v[102:103], v8 offset:29440
    ds_read_b64_tr_b16 v[104:105], v8 offset:28736
    s_waitcnt lgkmcnt(5)
    v_mfma_f32_32x32x16_bf16 v[64:79], v[128:131], v[116:119], v[64:79]
    ds_read_b64_tr_b16 v[106:107], v8 offset:29504
    ds_read_b64_tr_b16 v[108:109], v8 offset:28800
    s_waitcnt lgkmcnt(6)
    v_mfma_f32_32x32x16_bf16 v[80:95], v[116:119], v[132:135], v[80:95]
    ds_read_b64_tr_b16 v[110:111], v8 offset:29568
    ds_read_b128 v[112:115], v12 offset:12288
    s_waitcnt vmcnt(1)
    buffer_load_dwordx2 v[252:253], v254, s[44:47], s99 offen sc1
    buffer_load_dwordx4 v[244:247], v243, s[44:47], s98 offen offset:16 sc1
    buffer_load_dwordx4 v[248:251], v243, s[44:47], s98 offen sc1
    s_waitcnt lgkmcnt(5)
    v_mfma_f32_32x32x16_bf16 v[32:47], v[100:103], v[96:99], v[32:47]
    ds_read_b128 v[116:119], v5 offset:28672
    ds_read_b64_tr_b16 v[120:121], v9 offset:28672
    s_waitcnt lgkmcnt(5)
    v_mfma_f32_32x32x16_bf16 v[48:63], v[104:107], v[96:99], v[48:63]
    ds_read_b64_tr_b16 v[122:123], v9 offset:29440
    ds_read_b64_tr_b16 v[124:125], v9 offset:28736
    s_waitcnt lgkmcnt(5)
    v_mfma_f32_32x32x16_bf16 v[64:79], v[108:111], v[96:99], v[64:79]
    ds_read_b64_tr_b16 v[126:127], v9 offset:29504
    ds_read_b64_tr_b16 v[128:129], v9 offset:28800
    s_waitcnt lgkmcnt(6)
    v_mfma_f32_32x32x16_bf16 v[80:95], v[96:99], v[112:115], v[80:95]
    ds_read_b64_tr_b16 v[130:131], v9 offset:29568
    ds_read_b128 v[132:135], v13 offset:12288
    s_barrier
    v_add_u32 v2, 73728, v2
    v_add_u32 v3, 73728, v3
    v_add_u32 v4, 73728, v4
    v_add_u32 v5, 73728, v5
    v_add_u32 v6, 73728, v6
    v_add_u32 v7, 73728, v7
    v_add_u32 v8, 73728, v8
    v_add_u32 v9, 73728, v9
    s_waitcnt lgkmcnt(5)
    v_mfma_f32_32x32x16_bf16 v[32:47], v[120:123], v[116:119], v[32:47]
    ds_read_b128 v[96:99], v2 offset:0
    ds_read_b64_tr_b16 v[100:101], v6 offset:0
    s_waitcnt lgkmcnt(5)
    v_mfma_f32_32x32x16_bf16 v[48:63], v[124:127], v[116:119], v[48:63]
    ds_read_b64_tr_b16 v[102:103], v6 offset:768
    ds_read_b64_tr_b16 v[104:105], v6 offset:64
    s_waitcnt lgkmcnt(5)
    v_mfma_f32_32x32x16_bf16 v[64:79], v[128:131], v[116:119], v[64:79]
    ds_read_b64_tr_b16 v[106:107], v6 offset:832
    ds_read_b64_tr_b16 v[108:109], v6 offset:128
    s_waitcnt lgkmcnt(6)
    v_mfma_f32_32x32x16_bf16 v[80:95], v[116:119], v[132:135], v[80:95]
    ds_read_b64_tr_b16 v[110:111], v6 offset:896
    ds_read_b128 v[112:115], v10 offset:0
    s_waitcnt lgkmcnt(5)
    v_mfma_f32_32x32x16_bf16 v[32:47], v[100:103], v[96:99], v[32:47]
    ds_read_b128 v[116:119], v3 offset:0
    ds_read_b64_tr_b16 v[120:121], v7 offset:0
    s_waitcnt lgkmcnt(5)
    v_mfma_f32_32x32x16_bf16 v[48:63], v[104:107], v[96:99], v[48:63]
    ds_read_b64_tr_b16 v[122:123], v7 offset:768
    ds_read_b64_tr_b16 v[124:125], v7 offset:64
    s_nop 1
    v_xor_b32 v80, v15, v80
    v_xor_b32 v81, v15, v81
    v_xor_b32 v82, v15, v82
    v_xor_b32 v83, v15, v83
    v_xor_b32 v84, v15, v84
    v_xor_b32 v85, v15, v85
    v_xor_b32 v86, v15, v86
    v_xor_b32 v87, v15, v87
    s_waitcnt lgkmcnt(5)
    v_mfma_f32_32x32x16_bf16 v[64:79], v[108:111], v[96:99], v[64:79]
    ds_read_b64_tr_b16 v[126:127], v7 offset:832
    ds_read_b64_tr_b16 v[128:129], v7 offset:128
    v_xor_b32 v88, v15, v88
    v_xor_b32 v89, v15, v89
    v_xor_b32 v90, v15, v90
    v_xor_b32 v91, v15, v91
    v_xor_b32 v92, v15, v92
    v_xor_b32 v93, v15, v93
    v_xor_b32 v94, v15, v94
    v_xor_b32 v95, v15, v95
    s_waitcnt lgkmcnt(6)
    s_nop 0
    v_mfma_f32_32x32x16_bf16 v[80:95], v[96:99], v[112:115], v[80:95]
    ds_read_b64_tr_b16 v[130:131], v7 offset:896
    ds_read_b128 v[132:135], v11 offset:0
    v_mfma_f32_16x16x32_bf16 v[28:31], v[16:19], v[100:103], v[28:31]
    v_mfma_f32_16x16x32_bf16 v[28:31], v[20:23], v[104:107], v[28:31]
    v_mfma_f32_16x16x32_bf16 v[28:31], v[24:27], v[108:111], v[28:31]
    s_waitcnt lgkmcnt(5)
    v_mfma_f32_32x32x16_bf16 v[32:47], v[120:123], v[116:119], v[32:47]
    ds_read_b128 v[96:99], v4 offset:0
    ds_read_b64_tr_b16 v[100:101], v8 offset:0
    s_waitcnt lgkmcnt(5)
    v_mfma_f32_32x32x16_bf16 v[48:63], v[124:127], v[116:119], v[48:63]
    ds_read_b64_tr_b16 v[102:103], v8 offset:768
    ds_read_b64_tr_b16 v[104:105], v8 offset:64
    s_waitcnt lgkmcnt(5)
    v_mfma_f32_32x32x16_bf16 v[64:79], v[128:131], v[116:119], v[64:79]
    ds_read_b64_tr_b16 v[106:107], v8 offset:832
    ds_read_b64_tr_b16 v[108:109], v8 offset:128
    s_waitcnt lgkmcnt(6)
    v_mfma_f32_32x32x16_bf16 v[80:95], v[116:119], v[132:135], v[80:95]
    ds_read_b64_tr_b16 v[110:111], v8 offset:896
    ds_read_b128 v[112:115], v12 offset:0
    s_waitcnt lgkmcnt(5)
    v_mfma_f32_32x32x16_bf16 v[32:47], v[100:103], v[96:99], v[32:47]
    ds_read_b128 v[116:119], v5 offset:0
    ds_read_b64_tr_b16 v[120:121], v9 offset:0
    s_waitcnt lgkmcnt(5)
    v_mfma_f32_32x32x16_bf16 v[48:63], v[104:107], v[96:99], v[48:63]
    ds_read_b64_tr_b16 v[122:123], v9 offset:768
    ds_read_b64_tr_b16 v[124:125], v9 offset:64
    s_waitcnt lgkmcnt(5)
    v_mfma_f32_32x32x16_bf16 v[64:79], v[108:111], v[96:99], v[64:79]
    ds_read_b64_tr_b16 v[126:127], v9 offset:832
    ds_read_b64_tr_b16 v[128:129], v9 offset:128
    s_waitcnt lgkmcnt(6)
    v_mfma_f32_32x32x16_bf16 v[80:95], v[96:99], v[112:115], v[80:95]
    ds_read_b64_tr_b16 v[130:131], v9 offset:896
    ds_read_b128 v[132:135], v13 offset:0
    s_barrier
    v_subrev_u32 v2, 131072, v2
    v_subrev_u32 v3, 131072, v3
    v_subrev_u32 v4, 131072, v4
    v_subrev_u32 v5, 131072, v5
    v_subrev_u32 v6, 131072, v6
    v_subrev_u32 v7, 131072, v7
    v_subrev_u32 v8, 131072, v8
    v_subrev_u32 v9, 131072, v9
    s_waitcnt lgkmcnt(5)
    v_mfma_f32_32x32x16_bf16 v[32:47], v[120:123], v[116:119], v[32:47]
    ds_read_b128 v[96:99], v2 offset:0
    ds_read_b64_tr_b16 v[100:101], v6 offset:0
    s_waitcnt lgkmcnt(5)
    v_mfma_f32_32x32x16_bf16 v[48:63], v[124:127], v[116:119], v[48:63]
    ds_read_b64_tr_b16 v[102:103], v6 offset:768
    ds_read_b64_tr_b16 v[104:105], v6 offset:64
    s_waitcnt lgkmcnt(5)
    v_mfma_f32_32x32x16_bf16 v[64:79], v[128:131], v[116:119], v[64:79]
    ds_read_b64_tr_b16 v[106:107], v6 offset:832
    ds_read_b64_tr_b16 v[108:109], v6 offset:128
    s_waitcnt lgkmcnt(6)
    v_mfma_f32_32x32x16_bf16 v[80:95], v[116:119], v[132:135], v[80:95]
    ds_read_b64_tr_b16 v[110:111], v6 offset:896
    ds_read_b128 v[112:115], v10 offset:4096
    s_waitcnt lgkmcnt(5)
    v_mfma_f32_32x32x16_bf16 v[32:47], v[100:103], v[96:99], v[32:47]
    ds_read_b128 v[116:119], v3 offset:0
    ds_read_b64_tr_b16 v[120:121], v7 offset:0
    s_waitcnt lgkmcnt(5)
    v_mfma_f32_32x32x16_bf16 v[48:63], v[104:107], v[96:99], v[48:63]
    ds_read_b64_tr_b16 v[122:123], v7 offset:768
    ds_read_b64_tr_b16 v[124:125], v7 offset:64
    s_waitcnt lgkmcnt(5)
    v_mfma_f32_32x32x16_bf16 v[64:79], v[108:111], v[96:99], v[64:79]
    ds_read_b64_tr_b16 v[126:127], v7 offset:832
    ds_read_b64_tr_b16 v[128:129], v7 offset:128
    s_waitcnt lgkmcnt(6)
    v_mfma_f32_32x32x16_bf16 v[80:95], v[96:99], v[112:115], v[80:95]
    ds_read_b64_tr_b16 v[130:131], v7 offset:896
    ds_read_b128 v[132:135], v11 offset:4096
    v_mfma_f32_16x16x32_bf16 v[28:31], v[16:19], v[100:103], v[28:31]
    v_mfma_f32_16x16x32_bf16 v[28:31], v[20:23], v[104:107], v[28:31]
    v_mfma_f32_16x16x32_bf16 v[28:31], v[24:27], v[108:111], v[28:31]
    s_waitcnt lgkmcnt(5)
    v_mfma_f32_32x32x16_bf16 v[32:47], v[120:123], v[116:119], v[32:47]
    ds_read_b128 v[96:99], v4 offset:0
    ds_read_b64_tr_b16 v[100:101], v8 offset:0
    s_waitcnt lgkmcnt(5)
    v_mfma_f32_32x32x16_bf16 v[48:63], v[124:127], v[116:119], v[48:63]
    ds_read_b64_tr_b16 v[102:103], v8 offset:768
    ds_read_b64_tr_b16 v[104:105], v8 offset:64
    s_waitcnt lgkmcnt(5)
    v_mfma_f32_32x32x16_bf16 v[64:79], v[128:131], v[116:119], v[64:79]
    ds_read_b64_tr_b16 v[106:107], v8 offset:832
    ds_read_b64_tr_b16 v[108:109], v8 offset:128
    s_waitcnt lgkmcnt(6)
    v_mfma_f32_32x32x16_bf16 v[80:95], v[116:119], v[132:135], v[80:95]
    ds_read_b64_tr_b16 v[110:111], v8 offset:896
    ds_read_b128 v[112:115], v12 offset:4096
    s_waitcnt lgkmcnt(5)
    v_mfma_f32_32x32x16_bf16 v[32:47], v[100:103], v[96:99], v[32:47]
    ds_read_b128 v[116:119], v5 offset:0
    ds_read_b64_tr_b16 v[120:121], v9 offset:0
    s_waitcnt lgkmcnt(5)
    v_mfma_f32_32x32x16_bf16 v[48:63], v[104:107], v[96:99], v[48:63]
    ds_read_b64_tr_b16 v[122:123], v9 offset:768
    ds_read_b64_tr_b16 v[124:125], v9 offset:64
    s_waitcnt lgkmcnt(5)
    v_mfma_f32_32x32x16_bf16 v[64:79], v[108:111], v[96:99], v[64:79]
    ds_read_b64_tr_b16 v[126:127], v9 offset:832
    ds_read_b64_tr_b16 v[128:129], v9 offset:128
    s_waitcnt lgkmcnt(6)
    v_mfma_f32_32x32x16_bf16 v[80:95], v[96:99], v[112:115], v[80:95]
    ds_read_b64_tr_b16 v[130:131], v9 offset:896
    ds_read_b128 v[132:135], v13 offset:4096
    s_barrier
    s_waitcnt lgkmcnt(5)
    v_mfma_f32_32x32x16_bf16 v[32:47], v[120:123], v[116:119], v[32:47]
    ds_read_b128 v[96:99], v2 offset:28672
    ds_read_b128 v[112:115], v10 offset:8192
    s_waitcnt lgkmcnt(5)
    v_mfma_f32_32x32x16_bf16 v[48:63], v[124:127], v[116:119], v[48:63]
    ds_read_b128 v[136:139], v3 offset:28672
    ds_read_b128 v[204:207], v11 offset:8192
    s_waitcnt lgkmcnt(5)
    v_mfma_f32_32x32x16_bf16 v[64:79], v[128:131], v[116:119], v[64:79]
    ds_read_b128 v[140:143], v4 offset:28672
    ds_read_b128 v[208:211], v12 offset:8192
    s_waitcnt lgkmcnt(6)
    v_mfma_f32_32x32x16_bf16 v[80:95], v[116:119], v[132:135], v[80:95]
    ds_read_b128 v[144:147], v5 offset:28672
    ds_read_b128 v[212:215], v13 offset:8192
    s_waitcnt lgkmcnt(6)
    v_mfma_f32_32x32x16_bf16 v[80:95], v[96:99], v[112:115], v[80:95]
    ds_read_b128 v[148:151], v2 offset:57344
    ds_read_b128 v[216:219], v10 offset:12288
    s_waitcnt lgkmcnt(6)
    v_mfma_f32_32x32x16_bf16 v[80:95], v[136:139], v[204:207], v[80:95]
    ds_read_b128 v[152:155], v3 offset:57344
    ds_read_b128 v[132:135], v11 offset:12288
    s_waitcnt lgkmcnt(6)
    v_mfma_f32_32x32x16_bf16 v[80:95], v[140:143], v[208:211], v[80:95]
    ds_read_b128 v[228:231], v4 offset:57344
    ds_read_b128 v[112:115], v12 offset:12288
    s_waitcnt lgkmcnt(6)
    v_mfma_f32_32x32x16_bf16 v[80:95], v[144:147], v[212:215], v[80:95]
    ds_read_b128 v[116:119], v5 offset:57344
    ds_read_b128 v[204:207], v13 offset:12288
    s_waitcnt vmcnt(0)
    s_mov_b32 s42, 400000
Lrecp_19:
    v_xor_b32 v223, s35, v245
    v_xor_b32 v224, s35, v247
    v_xor_b32 v225, s35, v253
    v_or3_b32 v223, v223, v224, v225
    v_xor_b32 v224, s35, v249
    v_xor_b32 v225, s35, v251
    v_or3_b32 v223, v223, v224, v225
    v_cmp_ne_u32 vcc, 0, v223
    v_mov_b32 v232, v244
    v_mov_b32 v234, v246
    v_cndmask_b32 v224, v250, v248, s[6:7]
    v_lshl_add_u32 v225, v1, 2, s34
    s_nop 0
    s_cbranch_vccnz Lrecok_18_c
Lrecok_18:
    v_cmp_ne_u32 vcc, s37, v252
    ds_write_b32 v225, v224 offset:5120
    ds_write_b32 v225, v222 offset:6656
    s_nop 2
    s_cmp_eq_u64 vcc, 0
    s_cselect_b32 s97, 1, 0
    s_waitcnt lgkmcnt(8)
    v_mfma_f32_32x32x16_bf16 v[80:95], v[148:151], v[216:219], v[80:95]
    ds_read_b64_tr_b16 v[100:101], v6 offset:28672
    ds_read_b64_tr_b16 v[102:103], v6 offset:29440
    ds_write_b64 v160, v[158:159] offset:5632
    s_waitcnt lgkmcnt(9)
    v_mfma_f32_32x32x16_bf16 v[80:95], v[152:155], v[132:135], v[80:95]
    ds_read_b64_tr_b16 v[104:105], v6 offset:28736
    ds_read_b64_tr_b16 v[106:107], v6 offset:29504
    ds_read_b128 v[244:247], v227 offset:0
    ds_read_b128 v[248:251], v227 offset:32
    s_waitcnt lgkmcnt(11)
    v_mfma_f32_32x32x16_bf16 v[80:95], v[228:231], v[112:115], v[80:95]
    ds_read_b64_tr_b16 v[108:109], v6 offset:28800
    ds_read_b64_tr_b16 v[110:111], v6 offset:29568
    ds_read_b128 v[208:211], v240 offset:32
    ds_read_b128 v[212:215], v240 offset:64
    s_barrier
    s_waitcnt lgkmcnt(13)
    v_mfma_f32_32x32x16_bf16 v[80:95], v[116:119], v[204:207], v[80:95]
    ds_read_b64_tr_b16 v[120:121], v6 offset:57344
    ds_read_b64_tr_b16 v[122:123], v6 offset:58112
    ds_read_b128 v[216:219], v240 offset:96
    ds_read_b128 v[204:207], v240 offset:0
    s_waitcnt lgkmcnt(10)
    v_mfma_f32_32x32x16_bf16 v[32:47], v[100:103], v[96:99], v[32:47]
    ds_read_b64_tr_b16 v[124:125], v6 offset:57408
    ds_read_b64_tr_b16 v[126:127], v6 offset:58176
    ds_read_b128 v[132:135], v227 offset:64
    ds_read_b128 v[112:115], v227 offset:96
    s_lshl_b32 s40, s33, 13
    v_add_u32 v223, s40, v242
    v_mfma_f32_32x32x16_bf16 v[48:63], v[104:107], v[96:99], v[48:63]
    ds_read_b64_tr_b16 v[128:129], v6 offset:57472
    ds_read_b64_tr_b16 v[130:131], v6 offset:58240
    v_and_b32 v226, 31, v1
    v_lshl_add_u32 v226, v226, 2, s34
    s_waitcnt lgkmcnt(2)
    v_fma_f32 v80, v80, v204, v244
    v_fma_f32 v81, v81, v205, v245
    v_fma_f32 v82, v82, v206, v246
    v_fma_f32 v83, v83, v207, v247
    v_mfma_f32_32x32x16_bf16 v[64:79], v[108:111], v[96:99], v[64:79]
    v_mfma_f32_16x16x32_bf16 v[28:31], v[16:19], v[100:103], v[28:31]
    v_mfma_f32_16x16x32_bf16 v[28:31], v[20:23], v[104:107], v[28:31]
    v_mfma_f32_16x16x32_bf16 v[28:31], v[24:27], v[108:111], v[28:31]
    ds_read_b64_tr_b16 v[100:101], v7 offset:28672
    ds_read_b64_tr_b16 v[102:103], v7 offset:29440
    v_fma_f32 v84, v84, v208, v248
    v_fma_f32 v85, v85, v209, v249
    v_fma_f32 v86, v86, v210, v250
    v_fma_f32 v87, v87, v211, v251
    v_mfma_f32_32x32x16_bf16 v[32:47], v[120:123], v[148:151], v[32:47]
    ds_read_b64_tr_b16 v[104:105], v8 offset:28672
    ds_read_b64_tr_b16 v[106:107], v8 offset:29440
    v_fma_f32 v88, v88, v212, v132
    v_fma_f32 v89, v89, v213, v133
    v_fma_f32 v90, v90, v214, v134
    v_fma_f32 v91, v91, v215, v135
    s_waitcnt lgkmcnt(4)
    v_mfma_f32_32x32x16_bf16 v[48:63], v[124:127], v[148:151], v[48:63]
    ds_read_b64_tr_b16 v[108:109], v9 offset:28672
    ds_read_b64_tr_b16 v[110:111], v9 offset:29440
    v_fma_f32 v92, v92, v216, v112
    v_fma_f32 v93, v93, v217, v113
    v_fma_f32 v94, v94, v218, v114
    v_fma_f32 v95, v95, v219, v115
    v_mfma_f32_32x32x16_bf16 v[64:79], v[128:131], v[148:151], v[64:79]
    v_mfma_f32_16x16x32_bf16 v[28:31], v[16:19], v[120:123], v[28:31]
    v_mfma_f32_16x16x32_bf16 v[28:31], v[20:23], v[124:127], v[28:31]
    v_mfma_f32_16x16x32_bf16 v[28:31], v[24:27], v[128:131], v[28:31]
    ds_read_b64_tr_b16 v[120:121], v7 offset:57344
    ds_read_b64_tr_b16 v[122:123], v7 offset:58112
    v_sub_f32 v204, v80, v81
    v_add_f32 v205, v80, v81
    v_sub_f32 v206, v83, v82
    v_add_f32 v207, v83, v82
    s_waitcnt lgkmcnt(4)
    v_mfma_f32_32x32x16_bf16 v[32:47], v[100:103], v[136:139], v[32:47]
    ds_read_b64_tr_b16 v[124:125], v8 offset:57344
    ds_read_b64_tr_b16 v[126:127], v8 offset:58112
    v_fmac_f32 v204, v239, v206
    v_fmac_f32 v205, v239, v207
    v_sub_f32 v208, v84, v85
    v_add_f32 v209, v84, v85
    v_mfma_f32_32x32x16_bf16 v[32:47], v[104:107], v[140:143], v[32:47]
    ds_read_b64_tr_b16 v[128:129], v9 offset:57344
    ds_read_b64_tr_b16 v[130:131], v9 offset:58112
    v_sub_f32 v210, v87, v86
    v_add_f32 v211, v87, v86
    v_fmac_f32 v208, v239, v210
    v_fmac_f32 v209, v239, v211
    s_waitcnt lgkmcnt(4)
    v_mfma_f32_32x32x16_bf16 v[32:47], v[108:111], v[144:147], v[32:47]
    ds_read_b64_tr_b16 v[100:101], v7 offset:28736
    ds_read_b64_tr_b16 v[102:103], v7 offset:29504
    v_sub_f32 v212, v88, v89
    v_add_f32 v213, v88, v89
    v_sub_f32 v214, v91, v90
    v_add_f32 v215, v91, v90
    v_mfma_f32_32x32x16_bf16 v[32:47], v[120:123], v[152:155], v[32:47]
    ds_read_b64_tr_b16 v[104:105], v8 offset:28736
    ds_read_b64_tr_b16 v[106:107], v8 offset:29504
    v_fmac_f32 v212, v239, v214
    v_fmac_f32 v213, v239, v215
    v_sub_f32 v216, v92, v93
    v_add_f32 v217, v92, v93
    s_waitcnt lgkmcnt(4)
    v_mfma_f32_32x32x16_bf16 v[32:47], v[124:127], v[228:231], v[32:47]
    ds_read_b64_tr_b16 v[108:109], v9 offset:28736
    ds_read_b64_tr_b16 v[110:111], v9 offset:29504
    v_sub_f32 v218, v95, v94
    v_add_f32 v219, v95, v94
    v_fmac_f32 v216, v239, v218
    v_fmac_f32 v217, v239, v219
    v_mfma_f32_32x32x16_bf16 v[32:47], v[128:131], v[116:119], v[32:47]
    ds_read_b64_tr_b16 v[120:121], v7 offset:57408
    ds_read_b64_tr_b16 v[122:123], v7 offset:58176
    s_or_b32 s40, s31, s33
    s_cbranch_scc0 Lc_20
Lj_21:
    v_cvt_pk_bf16_f32 v84, v204, v208
    v_cvt_pk_bf16_f32 v86, v205, v209
    s_waitcnt lgkmcnt(4)
    v_mfma_f32_32x32x16_bf16 v[48:63], v[100:103], v[136:139], v[48:63]
    ds_read_b64_tr_b16 v[124:125], v8 offset:57408
    ds_read_b64_tr_b16 v[126:127], v8 offset:58176
    v_cvt_pk_bf16_f32 v85, v212, v216
    v_cvt_pk_bf16_f32 v87, v213, v217
    s_nop 0
    v_permlane32_swap_b32 v84, v86
    v_mfma_f32_32x32x16_bf16 v[48:63], v[104:107], v[140:143], v[48:63]
    ds_read_b64_tr_b16 v[128:129], v9 offset:57408
    ds_read_b64_tr_b16 v[130:131], v9 offset:58176
    v_permlane32_swap_b32 v85, v87
    s_nop 0
    buffer_store_dwordx4 v[84:87], v238, s[44:47], s95 offen sc1
    ds_read_b128 v[156:159], v235 offset:1024
    s_waitcnt lgkmcnt(5)
    v_mfma_f32_32x32x16_bf16 v[48:63], v[108:111], v[144:147], v[48:63]
    ds_read_b64_tr_b16 v[100:101], v7 offset:28800
    ds_read_b64_tr_b16 v[102:103], v7 offset:29568
    s_mov_b32 exec_hi, 0
    ds_write_b128 v223, v[28:31]
    s_mov_b32 exec_hi, -1
    ds_read_b128 v[160:163], v235 offset:1056
    v_mfma_f32_32x32x16_bf16 v[48:63], v[120:123], v[152:155], v[48:63]
    ds_read_b64_tr_b16 v[104:105], v8 offset:28800
    ds_read_b64_tr_b16 v[106:107], v8 offset:29568
    ds_read_b128 v[164:167], v235 offset:1088
    ds_read_b128 v[168:171], v235 offset:1120
    s_waitcnt lgkmcnt(9)
    v_mfma_f32_32x32x16_bf16 v[48:63], v[124:127], v[228:231], v[48:63]
    ds_read_b64_tr_b16 v[108:109], v9 offset:28800
    ds_read_b64_tr_b16 v[110:111], v9 offset:29568
    ds_read_b128 v[172:175], v235 offset:1152
    ds_read_b128 v[176:179], v235 offset:1184
    s_waitcnt lgkmcnt(9)
    s_barrier
    ds_read_b128 v[96:99], v242 offset:0
    ds_read_b128 v[112:115], v242 offset:8192
    ds_read_b128 v[132:135], v242 offset:16384
    ds_read_b128 v[148:151], v242 offset:24576
    v_mfma_f32_32x32x16_bf16 v[48:63], v[128:131], v[116:119], v[48:63]
    ds_read_b64_tr_b16 v[120:121], v7 offset:57472
    ds_read_b64_tr_b16 v[122:123], v7 offset:58240
    ds_read_b128 v[180:183], v235 offset:1216
    s_waitcnt lgkmcnt(13)
    v_mfma_f32_32x32x16_bf16 v[64:79], v[100:103], v[136:139], v[64:79]
    ds_read_b64_tr_b16 v[124:125], v8 offset:57472
    ds_read_b64_tr_b16 v[126:127], v8 offset:58240
    ds_read_b128 v[184:187], v235 offset:1248
    ds_read_b128 v[188:191], v235 offset:1280
    v_mfma_f32_32x32x16_bf16 v[64:79], v[104:107], v[140:143], v[64:79]
    ds_read_b64_tr_b16 v[128:129], v9 offset:57472
    ds_read_b64_tr_b16 v[130:131], v9 offset:58240
    ds_read_b128 v[192:195], v235 offset:1312
    ds_read_b128 v[196:199], v235 offset:1344
    s_waitcnt lgkmcnt(9)
    v_mfma_f32_32x32x16_bf16 v[64:79], v[108:111], v[144:147], v[64:79]
    ds_read_b128 v[200:203], v235 offset:1376
    v_mfma_f32_32x32x16_bf16 v[64:79], v[120:123], v[152:155], v[64:79]
    v_add_f32 v96, v96, v112
    v_add_f32 v97, v97, v113
    v_add_f32 v98, v98, v114
    v_add_f32 v132, v132, v148
    v_add_f32 v133, v133, v149
    s_waitcnt lgkmcnt(3)
    v_mfma_f32_32x32x16_bf16 v[64:79], v[124:127], v[228:231], v[64:79]
    v_add_f32 v134, v134, v150
    v_add_f32 v96, v96, v132
    v_add_f32 v97, v97, v133
    v_add_f32 v98, v98, v134
    v_mfma_f32_32x32x16_bf16 v[64:79], v[128:131], v[116:119], v[64:79]
    ds_write_b32 v226, v96 offset:4608
    ds_write_b32 v226, v97 offset:4736
    ds_write_b32 v226, v98 offset:4864
    ds_read_b128 v[128:131], v235 offset:0
    ds_read_b128 v[132:135], v235 offset:32
    ds_read_b128 v[136:139], v235 offset:64
    ds_read_b128 v[140:143], v235 offset:96
    ds_read_b128 v[144:147], v235 offset:128
    ds_read_b128 v[148:151], v235 offset:160
    s_waitcnt lgkmcnt(4)
    v_pk_fma_f32 v[156:157], v[128:129], v[234:235], v[156:157] op_sel_hi:[1,0,1] neg_lo:[0,1,0] neg_hi:[0,1,0]
    v_pk_fma_f32 v[158:159], v[130:131], v[234:235], v[158:159] op_sel_hi:[1,0,1] neg_lo:[0,1,0] neg_hi:[0,1,0]
    v_pk_fma_f32 v[160:161], v[132:133], v[234:235], v[160:161] op_sel_hi:[1,0,1] neg_lo:[0,1,0] neg_hi:[0,1,0]
    v_pk_fma_f32 v[162:163], v[134:135], v[234:235], v[162:163] op_sel_hi:[1,0,1] neg_lo:[0,1,0] neg_hi:[0,1,0]
    ds_read_b128 v[128:131], v235 offset:192
    ds_read_b128 v[132:135], v235 offset:224
    v_pk_fma_f32 v[32:33], v[32:33], v[232:233], v[156:157] op_sel_hi:[1,0,1]
    v_pk_fma_f32 v[34:35], v[34:35], v[232:233], v[158:159] op_sel_hi:[1,0,1]
    v_pk_fma_f32 v[36:37], v[36:37], v[232:233], v[160:161] op_sel_hi:[1,0,1]
    v_pk_fma_f32 v[38:39], v[38:39], v[232:233], v[162:163] op_sel_hi:[1,0,1]
    v_pk_mul_f32 v[204:205], v[32:33], v[32:33]
    v_pk_mul_f32 v[206:207], v[34:35], v[34:35]
    v_pk_mul_f32 v[208:209], v[36:37], v[36:37]
    v_pk_mul_f32 v[210:211], v[38:39], v[38:39]
    v_pk_fma_f32 v[204:205], v[204:205], s[100:101], v[236:237] op_sel_hi:[1,0,0]
    v_pk_fma_f32 v[206:207], v[206:207], s[100:101], v[236:237] op_sel_hi:[1,0,0]
    v_pk_fma_f32 v[208:209], v[208:209], s[100:101], v[236:237] op_sel_hi:[1,0,0]
    v_pk_fma_f32 v[210:211], v[210:211], s[100:101], v[236:237] op_sel_hi:[1,0,0]
    v_pk_mul_f32 v[204:205], v[204:205], v[32:33]
    v_pk_mul_f32 v[206:207], v[206:207], v[34:35]
    v_pk_mul_f32 v[208:209], v[208:209], v[36:37]
    v_pk_mul_f32 v[210:211], v[210:211], v[38:39]
    v_exp_f32 v204, v204
    v_exp_f32 v205, v205
    v_exp_f32 v206, v206
    v_exp_f32 v207, v207
    v_exp_f32 v208, v208
    v_exp_f32 v209, v209
    v_exp_f32 v210, v210
    v_exp_f32 v211, v211
    v_pk_add_f32 v[204:205], v[204:205], 1.0 op_sel_hi:[1,0]
    v_pk_add_f32 v[206:207], v[206:207], 1.0 op_sel_hi:[1,0]
    v_pk_add_f32 v[208:209], v[208:209], 1.0 op_sel_hi:[1,0]
    v_pk_add_f32 v[210:211], v[210:211], 1.0 op_sel_hi:[1,0]
    v_rcp_f32 v204, v204
    v_rcp_f32 v205, v205
    v_rcp_f32 v206, v206
    v_rcp_f32 v207, v207
    v_rcp_f32 v208, v208
    v_rcp_f32 v209, v209
    v_rcp_f32 v210, v210
    v_rcp_f32 v211, v211
    v_pk_mul_f32 v[32:33], v[32:33], v[204:205]
    v_pk_mul_f32 v[34:35], v[34:35], v[206:207]
    v_pk_mul_f32 v[36:37], v[36:37], v[208:209]
    v_pk_mul_f32 v[38:39], v[38:39], v[210:211]
    v_cvt_pk_bf16_f32 v216, v32, v33
    v_cvt_pk_bf16_f32 v217, v34, v35
    v_cvt_pk_bf16_f32 v218, v36, v37
    v_cvt_pk_bf16_f32 v219, v38, v39
    s_cmp_eq_u32 s97, 1
    v_permlane32_swap_b32 v216, v218
    v_permlane32_swap_b32 v217, v219
    s_cbranch_scc0 Lc_22
    buffer_store_dwordx4 v[216:219], v233, s[44:47], s88 offen offset:0 nt
Lj_23:
    s_waitcnt vmcnt(1)
    s_mov_b64 exec, 1
    buffer_store_dword v255, off, s[44:47], s94 sc0 sc1
    s_mov_b64 exec, -1
    s_waitcnt lgkmcnt(4)
    v_pk_fma_f32 v[164:165], v[136:137], v[234:235], v[164:165] op_sel_hi:[1,0,1] neg_lo:[0,1,0] neg_hi:[0,1,0]
    v_pk_fma_f32 v[166:167], v[138:139], v[234:235], v[166:167] op_sel_hi:[1,0,1] neg_lo:[0,1,0] neg_hi:[0,1,0]
    v_pk_fma_f32 v[168:169], v[140:141], v[234:235], v[168:169] op_sel_hi:[1,0,1] neg_lo:[0,1,0] neg_hi:[0,1,0]
    v_pk_fma_f32 v[170:171], v[142:143], v[234:235], v[170:171] op_sel_hi:[1,0,1] neg_lo:[0,1,0] neg_hi:[0,1,0]
    ds_read_b128 v[136:139], v235 offset:256
    ds_read_b128 v[140:143], v235 offset:288
    v_pk_fma_f32 v[40:41], v[40:41], v[232:233], v[164:165] op_sel_hi:[1,0,1]
    v_pk_fma_f32 v[42:43], v[42:43], v[232:233], v[166:167] op_sel_hi:[1,0,1]
    v_pk_fma_f32 v[44:45], v[44:45], v[232:233], v[168:169] op_sel_hi:[1,0,1]
    v_pk_fma_f32 v[46:47], v[46:47], v[232:233], v[170:171] op_sel_hi:[1,0,1]
    v_pk_mul_f32 v[204:205], v[40:41], v[40:41]
    v_pk_mul_f32 v[206:207], v[42:43], v[42:43]
    v_pk_mul_f32 v[208:209], v[44:45], v[44:45]
    v_pk_mul_f32 v[210:211], v[46:47], v[46:47]
    v_pk_fma_f32 v[204:205], v[204:205], s[100:101], v[236:237] op_sel_hi:[1,0,0]
    v_pk_fma_f32 v[206:207], v[206:207], s[100:101], v[236:237] op_sel_hi:[1,0,0]
    v_pk_fma_f32 v[208:209], v[208:209], s[100:101], v[236:237] op_sel_hi:[1,0,0]
    v_pk_fma_f32 v[210:211], v[210:211], s[100:101], v[236:237] op_sel_hi:[1,0,0]
    v_pk_mul_f32 v[204:205], v[204:205], v[40:41]
    v_pk_mul_f32 v[206:207], v[206:207], v[42:43]
    v_pk_mul_f32 v[208:209], v[208:209], v[44:45]
    v_pk_mul_f32 v[210:211], v[210:211], v[46:47]
    v_exp_f32 v204, v204
    v_exp_f32 v205, v205
    v_exp_f32 v206, v206
    v_exp_f32 v207, v207
    v_exp_f32 v208, v208
    v_exp_f32 v209, v209
    v_exp_f32 v210, v210
    v_exp_f32 v211, v211
    v_pk_add_f32 v[204:205], v[204:205], 1.0 op_sel_hi:[1,0]
    v_pk_add_f32 v[206:207], v[206:207], 1.0 op_sel_hi:[1,0]
    v_pk_add_f32 v[208:209], v[208:209], 1.0 op_sel_hi:[1,0]
    v_pk_add_f32 v[210:211], v[210:211], 1.0 op_sel_hi:[1,0]
    v_rcp_f32 v204, v204
    v_rcp_f32 v205, v205
    v_rcp_f32 v206, v206
    v_rcp_f32 v207, v207
    v_rcp_f32 v208, v208
    v_rcp_f32 v209, v209
    v_rcp_f32 v210, v210
    v_rcp_f32 v211, v211
    v_pk_mul_f32 v[40:41], v[40:41], v[204:205]
    v_pk_mul_f32 v[42:43], v[42:43], v[206:207]
    v_pk_mul_f32 v[44:45], v[44:45], v[208:209]
    v_pk_mul_f32 v[46:47], v[46:47], v[210:211]
    v_cvt_pk_bf16_f32 v220, v40, v41
    v_cvt_pk_bf16_f32 v221, v42, v43
    v_cvt_pk_bf16_f32 v222, v44, v45
    v_cvt_pk_bf16_f32 v223, v46, v47
    s_cmp_eq_u32 s97, 1
    v_permlane32_swap_b32 v220, v222
    v_permlane32_swap_b32 v221, v223
    s_cbranch_scc0 Lc_24
    buffer_store_dwordx4 v[220:223], v233, s[44:47], s88 offen offset:2048 nt
Lj_25:
    s_waitcnt lgkmcnt(4)
    v_pk_fma_f32 v[172:173], v[144:145], v[234:235], v[172:173] op_sel_hi:[1,0,1] neg_lo:[0,1,0] neg_hi:[0,1,0]
    v_pk_fma_f32 v[174:175], v[146:147], v[234:235], v[174:175] op_sel_hi:[1,0,1] neg_lo:[0,1,0] neg_hi:[0,1,0]
    v_pk_fma_f32 v[176:177], v[148:149], v[234:235], v[176:177] op_sel_hi:[1,0,1] neg_lo:[0,1,0] neg_hi:[0,1,0]
    v_pk_fma_f32 v[178:179], v[150:151], v[234:235], v[178:179] op_sel_hi:[1,0,1] neg_lo:[0,1,0] neg_hi:[0,1,0]
    ds_read_b128 v[144:147], v235 offset:320
    ds_read_b128 v[148:151], v235 offset:352
    v_pk_fma_f32 v[48:49], v[48:49], v[232:233], v[172:173] op_sel_hi:[1,0,1]
    v_pk_fma_f32 v[50:51], v[50:51], v[232:233], v[174:175] op_sel_hi:[1,0,1]
    v_pk_fma_f32 v[52:53], v[52:53], v[232:233], v[176:177] op_sel_hi:[1,0,1]
    v_pk_fma_f32 v[54:55], v[54:55], v[232:233], v[178:179] op_sel_hi:[1,0,1]
    v_pk_mul_f32 v[204:205], v[48:49], v[48:49]
    v_pk_mul_f32 v[206:207], v[50:51], v[50:51]
    v_pk_mul_f32 v[208:209], v[52:53], v[52:53]
    v_pk_mul_f32 v[210:211], v[54:55], v[54:55]
    v_pk_fma_f32 v[204:205], v[204:205], s[100:101], v[236:237] op_sel_hi:[1,0,0]
    v_pk_fma_f32 v[206:207], v[206:207], s[100:101], v[236:237] op_sel_hi:[1,0,0]
    v_pk_fma_f32 v[208:209], v[208:209], s[100:101], v[236:237] op_sel_hi:[1,0,0]
    v_pk_fma_f32 v[210:211], v[210:211], s[100:101], v[236:237] op_sel_hi:[1,0,0]
    v_pk_mul_f32 v[204:205], v[204:205], v[48:49]
    v_pk_mul_f32 v[206:207], v[206:207], v[50:51]
    v_pk_mul_f32 v[208:209], v[208:209], v[52:53]
    v_pk_mul_f32 v[210:211], v[210:211], v[54:55]
    v_exp_f32 v204, v204
    v_exp_f32 v205, v205
    v_exp_f32 v206, v206
    v_exp_f32 v207, v207
    v_exp_f32 v208, v208
    v_exp_f32 v209, v209
    v_exp_f32 v210, v210
    v_exp_f32 v211, v211
    v_pk_add_f32 v[204:205], v[204:205], 1.0 op_sel_hi:[1,0]
    v_pk_add_f32 v[206:207], v[206:207], 1.0 op_sel_hi:[1,0]
    v_pk_add_f32 v[208:209], v[208:209], 1.0 op_sel_hi:[1,0]
    v_pk_add_f32 v[210:211], v[210:211], 1.0 op_sel_hi:[1,0]
    v_rcp_f32 v204, v204
    v_rcp_f32 v205, v205
    v_rcp_f32 v206, v206
    v_rcp_f32 v207, v207
    v_rcp_f32 v208, v208
    v_rcp_f32 v209, v209
    v_rcp_f32 v210, v210
    v_rcp_f32 v211, v211
    v_pk_mul_f32 v[48:49], v[48:49], v[204:205]
    v_pk_mul_f32 v[50:51], v[50:51], v[206:207]
    v_pk_mul_f32 v[52:53], v[52:53], v[208:209]
    v_pk_mul_f32 v[54:55], v[54:55], v[210:211]
    v_cvt_pk_bf16_f32 v224, v48, v49
    v_cvt_pk_bf16_f32 v225, v50, v51
    v_cvt_pk_bf16_f32 v226, v52, v53
    v_cvt_pk_bf16_f32 v227, v54, v55
    s_cmp_eq_u32 s97, 1
    v_permlane32_swap_b32 v224, v226
    v_permlane32_swap_b32 v225, v227
    s_cbranch_scc0 Lc_26
    buffer_store_dwordx4 v[224:227], v233, s[44:47], s89 offen offset:0 nt
Lj_27:
    s_waitcnt vmcnt(1)
    s_mov_b64 exec, 1
    s_cmp_eq_u32 s97, 1
    s_cbranch_scc0 Lc_28
    buffer_store_dword v255, off, s[44:47], s91
Lj_29:
    s_mov_b64 exec, -1
    s_waitcnt lgkmcnt(4)
    v_pk_fma_f32 v[180:181], v[128:129], v[234:235], v[180:181] op_sel_hi:[1,0,1] neg_lo:[0,1,0] neg_hi:[0,1,0]
    v_pk_fma_f32 v[182:183], v[130:131], v[234:235], v[182:183] op_sel_hi:[1,0,1] neg_lo:[0,1,0] neg_hi:[0,1,0]
    v_pk_fma_f32 v[184:185], v[132:133], v[234:235], v[184:185] op_sel_hi:[1,0,1] neg_lo:[0,1,0] neg_hi:[0,1,0]
    v_pk_fma_f32 v[186:187], v[134:135], v[234:235], v[186:187] op_sel_hi:[1,0,1] neg_lo:[0,1,0] neg_hi:[0,1,0]
    v_pk_fma_f32 v[56:57], v[56:57], v[232:233], v[180:181] op_sel_hi:[1,0,1]
    v_pk_fma_f32 v[58:59], v[58:59], v[232:233], v[182:183] op_sel_hi:[1,0,1]
    v_pk_fma_f32 v[60:61], v[60:61], v[232:233], v[184:185] op_sel_hi:[1,0,1]
    v_pk_fma_f32 v[62:63], v[62:63], v[232:233], v[186:187] op_sel_hi:[1,0,1]
    v_pk_mul_f32 v[204:205], v[56:57], v[56:57]
    v_pk_mul_f32 v[206:207], v[58:59], v[58:59]
    v_pk_mul_f32 v[208:209], v[60:61], v[60:61]
    v_pk_mul_f32 v[210:211], v[62:63], v[62:63]
    v_pk_fma_f32 v[204:205], v[204:205], s[100:101], v[236:237] op_sel_hi:[1,0,0]
    v_pk_fma_f32 v[206:207], v[206:207], s[100:101], v[236:237] op_sel_hi:[1,0,0]
    v_pk_fma_f32 v[208:209], v[208:209], s[100:101], v[236:237] op_sel_hi:[1,0,0]
    v_pk_fma_f32 v[210:211], v[210:211], s[100:101], v[236:237] op_sel_hi:[1,0,0]
    v_pk_mul_f32 v[204:205], v[204:205], v[56:57]
    v_pk_mul_f32 v[206:207], v[206:207], v[58:59]
    v_pk_mul_f32 v[208:209], v[208:209], v[60:61]
    v_pk_mul_f32 v[210:211], v[210:211], v[62:63]
    v_exp_f32 v204, v204
    v_exp_f32 v205, v205
    v_exp_f32 v206, v206
    v_exp_f32 v207, v207
    v_exp_f32 v208, v208
    v_exp_f32 v209, v209
    v_exp_f32 v210, v210
    v_exp_f32 v211, v211
    v_pk_add_f32 v[204:205], v[204:205], 1.0 op_sel_hi:[1,0]
    v_pk_add_f32 v[206:207], v[206:207], 1.0 op_sel_hi:[1,0]
    v_pk_add_f32 v[208:209], v[208:209], 1.0 op_sel_hi:[1,0]
    v_pk_add_f32 v[210:211], v[210:211], 1.0 op_sel_hi:[1,0]
    v_rcp_f32 v204, v204
    v_rcp_f32 v205, v205
    v_rcp_f32 v206, v206
    v_rcp_f32 v207, v207
    v_rcp_f32 v208, v208
    v_rcp_f32 v209, v209
    v_rcp_f32 v210, v210
    v_rcp_f32 v211, v211
    v_pk_mul_f32 v[56:57], v[56:57], v[204:205]
    v_pk_mul_f32 v[58:59], v[58:59], v[206:207]
    v_pk_mul_f32 v[60:61], v[60:61], v[208:209]
    v_pk_mul_f32 v[62:63], v[62:63], v[210:211]
    v_cvt_pk_bf16_f32 v216, v56, v57
    v_cvt_pk_bf16_f32 v217, v58, v59
    v_cvt_pk_bf16_f32 v218, v60, v61
    v_cvt_pk_bf16_f32 v219, v62, v63
    s_cmp_eq_u32 s97, 1
    v_permlane32_swap_b32 v216, v218
    v_permlane32_swap_b32 v217, v219
    s_cbranch_scc0 Lc_30
    buffer_store_dwordx4 v[216:219], v233, s[44:47], s89 offen offset:2048 nt
Lj_31:
    s_cmp_ge_u32 s32, 11
    s_cbranch_scc1 L_NO2
    s_waitcnt lgkmcnt(2)
    v_pk_fma_f32 v[188:189], v[136:137], v[234:235], v[188:189] op_sel_hi:[1,0,1] neg_lo:[0,1,0] neg_hi:[0,1,0]
    v_pk_fma_f32 v[190:191], v[138:139], v[234:235], v[190:191] op_sel_hi:[1,0,1] neg_lo:[0,1,0] neg_hi:[0,1,0]
    v_pk_fma_f32 v[192:193], v[140:141], v[234:235], v[192:193] op_sel_hi:[1,0,1] neg_lo:[0,1,0] neg_hi:[0,1,0]
    v_pk_fma_f32 v[194:195], v[142:143], v[234:235], v[194:195] op_sel_hi:[1,0,1] neg_lo:[0,1,0] neg_hi:[0,1,0]
    v_pk_fma_f32 v[64:65], v[64:65], v[232:233], v[188:189] op_sel_hi:[1,0,1]
    v_pk_fma_f32 v[66:67], v[66:67], v[232:233], v[190:191] op_sel_hi:[1,0,1]
    v_pk_fma_f32 v[68:69], v[68:69], v[232:233], v[192:193] op_sel_hi:[1,0,1]
    v_pk_fma_f32 v[70:71], v[70:71], v[232:233], v[194:195] op_sel_hi:[1,0,1]
    v_pk_mul_f32 v[204:205], v[64:65], v[64:65]
    v_pk_mul_f32 v[206:207], v[66:67], v[66:67]
    v_pk_mul_f32 v[208:209], v[68:69], v[68:69]
    v_pk_mul_f32 v[210:211], v[70:71], v[70:71]
    v_pk_fma_f32 v[204:205], v[204:205], s[100:101], v[236:237] op_sel_hi:[1,0,0]
    v_pk_fma_f32 v[206:207], v[206:207], s[100:101], v[236:237] op_sel_hi:[1,0,0]
    v_pk_fma_f32 v[208:209], v[208:209], s[100:101], v[236:237] op_sel_hi:[1,0,0]
    v_pk_fma_f32 v[210:211], v[210:211], s[100:101], v[236:237] op_sel_hi:[1,0,0]
    v_pk_mul_f32 v[204:205], v[204:205], v[64:65]
    v_pk_mul_f32 v[206:207], v[206:207], v[66:67]
    v_pk_mul_f32 v[208:209], v[208:209], v[68:69]
    v_pk_mul_f32 v[210:211], v[210:211], v[70:71]
    v_exp_f32 v204, v204
    v_exp_f32 v205, v205
    v_exp_f32 v206, v206
    v_exp_f32 v207, v207
    v_exp_f32 v208, v208
    v_exp_f32 v209, v209
    v_exp_f32 v210, v210
    v_exp_f32 v211, v211
    v_pk_add_f32 v[204:205], v[204:205], 1.0 op_sel_hi:[1,0]
    v_pk_add_f32 v[206:207], v[206:207], 1.0 op_sel_hi:[1,0]
    v_pk_add_f32 v[208:209], v[208:209], 1.0 op_sel_hi:[1,0]
    v_pk_add_f32 v[210:211], v[210:211], 1.0 op_sel_hi:[1,0]
    v_rcp_f32 v204, v204
    v_rcp_f32 v205, v205
    v_rcp_f32 v206, v206
    v_rcp_f32 v207, v207
    v_rcp_f32 v208, v208
    v_rcp_f32 v209, v209
    v_rcp_f32 v210, v210
    v_rcp_f32 v211, v211
    v_pk_mul_f32 v[64:65], v[64:65], v[204:205]
    v_pk_mul_f32 v[66:67], v[66:67], v[206:207]
    v_pk_mul_f32 v[68:69], v[68:69], v[208:209]
    v_pk_mul_f32 v[70:71], v[70:71], v[210:211]
    v_cvt_pk_bf16_f32 v220, v64, v65
    v_cvt_pk_bf16_f32 v221, v66, v67
    v_cvt_pk_bf16_f32 v222, v68, v69
    v_cvt_pk_bf16_f32 v223, v70, v71
    s_cmp_eq_u32 s97, 1
    v_permlane32_swap_b32 v220, v222
    v_permlane32_swap_b32 v221, v223
    s_cbranch_scc0 Lc_32
    buffer_store_dwordx4 v[220:223], v233, s[44:47], s90 offen offset:0 nt
Lj_33:
    s_waitcnt vmcnt(1)
    s_mov_b64 exec, 1
    s_cmp_eq_u32 s97, 1
    s_cbranch_scc0 Lc_34
    buffer_store_dword v255, off, s[44:47], s92
Lj_35:
    s_mov_b64 exec, -1
    s_mov_b32 s92, s93
    s_waitcnt lgkmcnt(0)
    v_pk_fma_f32 v[196:197], v[144:145], v[234:235], v[196:197] op_sel_hi:[1,0,1] neg_lo:[0,1,0] neg_hi:[0,1,0]
    v_pk_fma_f32 v[198:199], v[146:147], v[234:235], v[198:199] op_sel_hi:[1,0,1] neg_lo:[0,1,0] neg_hi:[0,1,0]
    v_pk_fma_f32 v[200:201], v[148:149], v[234:235], v[200:201] op_sel_hi:[1,0,1] neg_lo:[0,1,0] neg_hi:[0,1,0]
    v_pk_fma_f32 v[202:203], v[150:151], v[234:235], v[202:203] op_sel_hi:[1,0,1] neg_lo:[0,1,0] neg_hi:[0,1,0]
    v_pk_fma_f32 v[72:73], v[72:73], v[232:233], v[196:197] op_sel_hi:[1,0,1]
    v_pk_fma_f32 v[74:75], v[74:75], v[232:233], v[198:199] op_sel_hi:[1,0,1]
    v_pk_fma_f32 v[76:77], v[76:77], v[232:233], v[200:201] op_sel_hi:[1,0,1]
    v_pk_fma_f32 v[78:79], v[78:79], v[232:233], v[202:203] op_sel_hi:[1,0,1]
    v_pk_mul_f32 v[204:205], v[72:73], v[72:73]
    v_pk_mul_f32 v[206:207], v[74:75], v[74:75]
    v_pk_mul_f32 v[208:209], v[76:77], v[76:77]
    v_pk_mul_f32 v[210:211], v[78:79], v[78:79]
    v_pk_fma_f32 v[204:205], v[204:205], s[100:101], v[236:237] op_sel_hi:[1,0,0]
    v_pk_fma_f32 v[206:207], v[206:207], s[100:101], v[236:237] op_sel_hi:[1,0,0]
    v_pk_fma_f32 v[208:209], v[208:209], s[100:101], v[236:237] op_sel_hi:[1,0,0]
    v_pk_fma_f32 v[210:211], v[210:211], s[100:101], v[236:237] op_sel_hi:[1,0,0]
    v_pk_mul_f32 v[204:205], v[204:205], v[72:73]
    v_pk_mul_f32 v[206:207], v[206:207], v[74:75]
    v_pk_mul_f32 v[208:209], v[208:209], v[76:77]
    v_pk_mul_f32 v[210:211], v[210:211], v[78:79]
    v_exp_f32 v204, v204
    v_exp_f32 v205, v205
    v_exp_f32 v206, v206
    v_exp_f32 v207, v207
    v_exp_f32 v208, v208
    v_exp_f32 v209, v209
    v_exp_f32 v210, v210
    v_exp_f32 v211, v211
    v_pk_add_f32 v[204:205], v[204:205], 1.0 op_sel_hi:[1,0]
    v_pk_add_f32 v[206:207], v[206:207], 1.0 op_sel_hi:[1,0]
    v_pk_add_f32 v[208:209], v[208:209], 1.0 op_sel_hi:[1,0]
    v_pk_add_f32 v[210:211], v[210:211], 1.0 op_sel_hi:[1,0]
    v_rcp_f32 v204, v204
    v_rcp_f32 v205, v205
    v_rcp_f32 v206, v206
    v_rcp_f32 v207, v207
    v_rcp_f32 v208, v208
    v_rcp_f32 v209, v209
    v_rcp_f32 v210, v210
    v_rcp_f32 v211, v211
    v_pk_mul_f32 v[72:73], v[72:73], v[204:205]
    v_pk_mul_f32 v[74:75], v[74:75], v[206:207]
    v_pk_mul_f32 v[76:77], v[76:77], v[208:209]
    v_pk_mul_f32 v[78:79], v[78:79], v[210:211]
    v_cvt_pk_bf16_f32 v224, v72, v73
    v_cvt_pk_bf16_f32 v225, v74, v75
    v_cvt_pk_bf16_f32 v226, v76, v77
    v_cvt_pk_bf16_f32 v227, v78, v79
    s_cmp_eq_u32 s97, 1
    v_permlane32_swap_b32 v224, v226
    v_permlane32_swap_b32 v225, v227
    s_cbranch_scc0 Lc_36
    buffer_store_dwordx4 v[224:227], v233, s[44:47], s90 offen offset:2048 nt
Lj_37:
L_NO2:
    s_waitcnt lgkmcnt(0)
    s_lshr_b32 s0, s31, 2
    s_and_b32 s40, s31, 1
    s_lshl1_add_u32 s0, s0, s40
    s_bfe_u32 s1, s31, 0x10001
    s_lshl_b32 s0, s0, 6
    s_or_b32 s0, s0, s1
    s_lshl1_add_u32 s0, s38, s0
    v_and_b32 v192, 30, v1
    v_lshl_add_u32 v192, v192, 1, s0
    v_and_b32 v193, 1, v1
    v_cmp_eq_u32 vcc, 1, v193
    v_sub_u32 v193, 1024, v192
    v_mov_b32 v194, 512
    v_cndmask_b32 v192, v192, v193, vcc
    v_cmp_eq_u32 vcc, 1024, v192
    v_lshrrev_b32 v193, 5, v1
    s_and_b32 s40, s33, 1
    v_cndmask_b32 v192, v192, v194, vcc
    s_lshl_b32 s40, s40, 8
    v_lshl_add_u32 v194, v193, 7, s40
    s_lshr_b32 s41, s33, 1
    s_lshl_b32 s41, s41, 9
    v_mad_u32_u24 v194, v194, v192, s41
    v_and_b32 v194, 2047, v194
    v_cvt_f32_u32 v228, v194
    v_cvt_f32_u32 v230, v192
    v_mul_f32 v228, 0x3a000000, v228
    v_mul_f32 v230, 0x3a800000, v230
    v_cos_f32 v190, v230
    v_mul_f32 v188, 0x41000000, v230
    v_fma_f32 v229, 0.5, v230, v228
    v_add_f32 v190, v190, v190
    v_pk_add_f32 v[162:163], v[228:229], v[230:231] op_sel_hi:[1,0]
    v_cos_f32 v160, v228
    v_cos_f32 v161, v229
    v_cos_f32 v162, v162
    v_cos_f32 v163, v163
    v_pk_add_f32 v[228:229], v[228:229], v[188:189] op_sel_hi:[1,0]
    v_pk_fma_f32 v[164:165], v[162:163], v[190:191], v[160:161] op_sel_hi:[1,0,1] neg_lo:[0,0,1] neg_hi:[0,0,1]
    v_pk_fma_f32 v[166:167], v[164:165], v[190:191], v[162:163] op_sel_hi:[1,0,1] neg_lo:[0,0,1] neg_hi:[0,0,1]
    v_cvt_pk_bf16_f32 v32, v160, v162
    v_cvt_pk_bf16_f32 v64, v161, v163
    v_pk_fma_f32 v[168:169], v[166:167], v[190:191], v[164:165] op_sel_hi:[1,0,1] neg_lo:[0,0,1] neg_hi:[0,0,1]
    v_pk_fma_f32 v[170:171], v[168:169], v[190:191], v[166:167] op_sel_hi:[1,0,1] neg_lo:[0,0,1] neg_hi:[0,0,1]
    v_cvt_pk_bf16_f32 v33, v164, v166
    v_cvt_pk_bf16_f32 v65, v165, v167
    v_pk_fma_f32 v[172:173], v[170:171], v[190:191], v[168:169] op_sel_hi:[1,0,1] neg_lo:[0,0,1] neg_hi:[0,0,1]
    v_pk_fma_f32 v[174:175], v[172:173], v[190:191], v[170:171] op_sel_hi:[1,0,1] neg_lo:[0,0,1] neg_hi:[0,0,1]
    v_cvt_pk_bf16_f32 v34, v168, v170
    v_cvt_pk_bf16_f32 v66, v169, v171
    v_cvt_pk_bf16_f32 v35, v172, v174
    v_cvt_pk_bf16_f32 v67, v173, v175
    v_pk_add_f32 v[162:163], v[228:229], v[230:231] op_sel_hi:[1,0]
    v_cos_f32 v160, v228
    v_cos_f32 v161, v229
    v_cos_f32 v162, v162
    v_cos_f32 v163, v163
    v_pk_add_f32 v[228:229], v[228:229], v[188:189] op_sel_hi:[1,0]
    v_pk_fma_f32 v[164:165], v[162:163], v[190:191], v[160:161] op_sel_hi:[1,0,1] neg_lo:[0,0,1] neg_hi:[0,0,1]
    v_pk_fma_f32 v[166:167], v[164:165], v[190:191], v[162:163] op_sel_hi:[1,0,1] neg_lo:[0,0,1] neg_hi:[0,0,1]
    v_cvt_pk_bf16_f32 v36, v160, v162
    v_cvt_pk_bf16_f32 v68, v161, v163
    v_pk_fma_f32 v[168:169], v[166:167], v[190:191], v[164:165] op_sel_hi:[1,0,1] neg_lo:[0,0,1] neg_hi:[0,0,1]
    v_pk_fma_f32 v[170:171], v[168:169], v[190:191], v[166:167] op_sel_hi:[1,0,1] neg_lo:[0,0,1] neg_hi:[0,0,1]
    v_cvt_pk_bf16_f32 v37, v164, v166
    v_cvt_pk_bf16_f32 v69, v165, v167
    v_pk_fma_f32 v[172:173], v[170:171], v[190:191], v[168:169] op_sel_hi:[1,0,1] neg_lo:[0,0,1] neg_hi:[0,0,1]
    v_pk_fma_f32 v[174:175], v[172:173], v[190:191], v[170:171] op_sel_hi:[1,0,1] neg_lo:[0,0,1] neg_hi:[0,0,1]
    v_cvt_pk_bf16_f32 v38, v168, v170
    v_cvt_pk_bf16_f32 v70, v169, v171
    v_cvt_pk_bf16_f32 v39, v172, v174
    v_cvt_pk_bf16_f32 v71, v173, v175
    v_pk_add_f32 v[162:163], v[228:229], v[230:231] op_sel_hi:[1,0]
    v_cos_f32 v160, v228
    v_cos_f32 v161, v229
    v_cos_f32 v162, v162
    v_cos_f32 v163, v163
    v_pk_add_f32 v[228:229], v[228:229], v[188:189] op_sel_hi:[1,0]
    v_pk_fma_f32 v[164:165], v[162:163], v[190:191], v[160:161] op_sel_hi:[1,0,1] neg_lo:[0,0,1] neg_hi:[0,0,1]
    v_pk_fma_f32 v[166:167], v[164:165], v[190:191], v[162:163] op_sel_hi:[1,0,1] neg_lo:[0,0,1] neg_hi:[0,0,1]
    v_cvt_pk_bf16_f32 v40, v160, v162
    v_cvt_pk_bf16_f32 v72, v161, v163
    v_pk_fma_f32 v[168:169], v[166:167], v[190:191], v[164:165] op_sel_hi:[1,0,1] neg_lo:[0,0,1] neg_hi:[0,0,1]
    v_pk_fma_f32 v[170:171], v[168:169], v[190:191], v[166:167] op_sel_hi:[1,0,1] neg_lo:[0,0,1] neg_hi:[0,0,1]
    v_cvt_pk_bf16_f32 v41, v164, v166
    v_cvt_pk_bf16_f32 v73, v165, v167
    v_pk_fma_f32 v[172:173], v[170:171], v[190:191], v[168:169] op_sel_hi:[1,0,1] neg_lo:[0,0,1] neg_hi:[0,0,1]
    v_pk_fma_f32 v[174:175], v[172:173], v[190:191], v[170:171] op_sel_hi:[1,0,1] neg_lo:[0,0,1] neg_hi:[0,0,1]
    v_cvt_pk_bf16_f32 v42, v168, v170
    v_cvt_pk_bf16_f32 v74, v169, v171
    v_cvt_pk_bf16_f32 v43, v172, v174
    v_cvt_pk_bf16_f32 v75, v173, v175
    s_waitcnt vmcnt(0)
    s_mov_b64 exec, 1
    s_cmp_eq_u32 s97, 1
    s_cbranch_scc0 Lc_38
    buffer_store_dword v255, off, s[44:47], s92
Lj_39:
    s_mov_b64 exec, -1
    v_and_b32 v204, 31, v1
    v_lshrrev_b32 v205, 5, v1
    v_mul_u32_u24 v2, 67584, v205
    v_lshl_add_u32 v2, v204, 4, v2
    v_mul_u32_u24 v3, 4224, v204
    v_add_u32 v3, 512, v3
    s_lshr_b32 s87, s33, 1
    s_and_b32 s86, s33, 1
    s_lshl1_add_u32 s84, s1, s87
    s_mul_i32 s84, s84, 270336
    s_mul_i32 s85, s86, 135168
    s_add_u32 s84, s84, s85
    s_lshl_b32 s85, s39, 9
    s_add_u32 s84, s84, s85
    s_add_u32 s96, s84, 1048576
    s_lshl3_add_u32 s84, s87, s39
    s_add_u32 s85, s84, 1
    s_cmp_eq_u32 s39, 7
    s_cselect_b32 s85, 8, s85
    s_lshl1_add_u32 s84, s84, s86
    s_lshl1_add_u32 s85, s85, s86
    s_lshl_b32 s84, s84, 7
    s_lshl_b32 s85, s85, 7
    s_add_u32 s84, s84, 65536
    s_add_u32 s85, s85, 65408
    v_mov_b32 v206, s84
    v_mov_b32 v207, s85
    v_cmp_gt_u32 vcc, 8, v1
    v_sub_u32 v208, 64, v1
    v_cndmask_b32 v208, v208, v1, s[6:7]
    v_cndmask_b32 v206, v207, v206, vcc
    v_lshl_add_u32 v5, v1, 4, v206
    s_lshl_b32 s84, s1, 11
    s_lshl_b32 s85, s39, 7
    s_add_u32 s84, s84, s85
    s_add_u32 s84, s84, 393216
    v_lshl_add_u32 v4, v208, 2, s84
    s_mov_b32 s41, 400000
    s_mov_b64 exec, 0xffff
    buffer_load_dwordx4 v[208:211], v5, s[44:47], 0 offen sc1
    s_mov_b64 exec, -1
L_ANP:
    v_pk_add_f32 v[162:163], v[228:229], v[230:231] op_sel_hi:[1,0]
    v_cos_f32 v160, v228
    v_cos_f32 v161, v229
    v_cos_f32 v162, v162
    v_cos_f32 v163, v163
    v_pk_add_f32 v[228:229], v[228:229], v[188:189] op_sel_hi:[1,0]
    v_pk_fma_f32 v[164:165], v[162:163], v[190:191], v[160:161] op_sel_hi:[1,0,1] neg_lo:[0,0,1] neg_hi:[0,0,1]
    v_pk_fma_f32 v[166:167], v[164:165], v[190:191], v[162:163] op_sel_hi:[1,0,1] neg_lo:[0,0,1] neg_hi:[0,0,1]
    v_cvt_pk_bf16_f32 v44, v160, v162
    v_cvt_pk_bf16_f32 v76, v161, v163
    v_pk_fma_f32 v[168:169], v[166:167], v[190:191], v[164:165] op_sel_hi:[1,0,1] neg_lo:[0,0,1] neg_hi:[0,0,1]
    v_pk_fma_f32 v[170:171], v[168:169], v[190:191], v[166:167] op_sel_hi:[1,0,1] neg_lo:[0,0,1] neg_hi:[0,0,1]
    v_cvt_pk_bf16_f32 v45, v164, v166
    v_cvt_pk_bf16_f32 v77, v165, v167
    v_pk_fma_f32 v[172:173], v[170:171], v[190:191], v[168:169] op_sel_hi:[1,0,1] neg_lo:[0,0,1] neg_hi:[0,0,1]
    v_pk_fma_f32 v[174:175], v[172:173], v[190:191], v[170:171] op_sel_hi:[1,0,1] neg_lo:[0,0,1] neg_hi:[0,0,1]
    v_cvt_pk_bf16_f32 v46, v168, v170
    v_cvt_pk_bf16_f32 v78, v169, v171
    v_cvt_pk_bf16_f32 v47, v172, v174
    v_cvt_pk_bf16_f32 v79, v173, v175
    v_pk_add_f32 v[162:163], v[228:229], v[230:231] op_sel_hi:[1,0]
    v_cos_f32 v160, v228
    v_cos_f32 v161, v229
    v_cos_f32 v162, v162
    v_cos_f32 v163, v163
    v_pk_add_f32 v[228:229], v[228:229], v[188:189] op_sel_hi:[1,0]
    v_pk_fma_f32 v[164:165], v[162:163], v[190:191], v[160:161] op_sel_hi:[1,0,1] neg_lo:[0,0,1] neg_hi:[0,0,1]
    v_pk_fma_f32 v[166:167], v[164:165], v[190:191], v[162:163] op_sel_hi:[1,0,1] neg_lo:[0,0,1] neg_hi:[0,0,1]
    v_cvt_pk_bf16_f32 v48, v160, v162
    v_cvt_pk_bf16_f32 v80, v161, v163
    v_pk_fma_f32 v[168:169], v[166:167], v[190:191], v[164:165] op_sel_hi:[1,0,1] neg_lo:[0,0,1] neg_hi:[0,0,1]
    v_pk_fma_f32 v[170:171], v[168:169], v[190:191], v[166:167] op_sel_hi:[1,0,1] neg_lo:[0,0,1] neg_hi:[0,0,1]
    v_cvt_pk_bf16_f32 v49, v164, v166
    v_cvt_pk_bf16_f32 v81, v165, v167
    v_pk_fma_f32 v[172:173], v[170:171], v[190:191], v[168:169] op_sel_hi:[1,0,1] neg_lo:[0,0,1] neg_hi:[0,0,1]
    v_pk_fma_f32 v[174:175], v[172:173], v[190:191], v[170:171] op_sel_hi:[1,0,1] neg_lo:[0,0,1] neg_hi:[0,0,1]
    v_cvt_pk_bf16_f32 v50, v168, v170
    v_cvt_pk_bf16_f32 v82, v169, v171
    v_cvt_pk_bf16_f32 v51, v172, v174
    v_cvt_pk_bf16_f32 v83, v173, v175
    v_pk_add_f32 v[162:163], v[228:229], v[230:231] op_sel_hi:[1,0]
    v_cos_f32 v160, v228
    v_cos_f32 v161, v229
    v_cos_f32 v162, v162
    v_cos_f32 v163, v163
    v_pk_add_f32 v[228:229], v[228:229], v[188:189] op_sel_hi:[1,0]
    v_pk_fma_f32 v[164:165], v[162:163], v[190:191], v[160:161] op_sel_hi:[1,0,1] neg_lo:[0,0,1] neg_hi:[0,0,1]
    v_pk_fma_f32 v[166:167], v[164:165], v[190:191], v[162:163] op_sel_hi:[1,0,1] neg_lo:[0,0,1] neg_hi:[0,0,1]
    v_cvt_pk_bf16_f32 v52, v160, v162
    v_cvt_pk_bf16_f32 v84, v161, v163
    v_pk_fma_f32 v[168:169], v[166:167], v[190:191], v[164:165] op_sel_hi:[1,0,1] neg_lo:[0,0,1] neg_hi:[0,0,1]
    v_pk_fma_f32 v[170:171], v[168:169], v[190:191], v[166:167] op_sel_hi:[1,0,1] neg_lo:[0,0,1] neg_hi:[0,0,1]
    v_cvt_pk_bf16_f32 v53, v164, v166
    v_cvt_pk_bf16_f32 v85, v165, v167
    v_pk_fma_f32 v[172:173], v[170:171], v[190:191], v[168:169] op_sel_hi:[1,0,1] neg_lo:[0,0,1] neg_hi:[0,0,1]
    v_pk_fma_f32 v[174:175], v[172:173], v[190:191], v[170:171] op_sel_hi:[1,0,1] neg_lo:[0,0,1] neg_hi:[0,0,1]
    v_cvt_pk_bf16_f32 v54, v168, v170
    v_cvt_pk_bf16_f32 v86, v169, v171
    v_cvt_pk_bf16_f32 v55, v172, v174
    v_cvt_pk_bf16_f32 v87, v173, v175
    v_pk_add_f32 v[162:163], v[228:229], v[230:231] op_sel_hi:[1,0]
    v_cos_f32 v160, v228
    v_cos_f32 v161, v229
    v_cos_f32 v162, v162
    v_cos_f32 v163, v163
    v_pk_add_f32 v[228:229], v[228:229], v[188:189] op_sel_hi:[1,0]
    v_pk_fma_f32 v[164:165], v[162:163], v[190:191], v[160:161] op_sel_hi:[1,0,1] neg_lo:[0,0,1] neg_hi:[0,0,1]
    v_pk_fma_f32 v[166:167], v[164:165], v[190:191], v[162:163] op_sel_hi:[1,0,1] neg_lo:[0,0,1] neg_hi:[0,0,1]
    v_cvt_pk_bf16_f32 v56, v160, v162
    v_cvt_pk_bf16_f32 v88, v161, v163
    v_pk_fma_f32 v[168:169], v[166:167], v[190:191], v[164:165] op_sel_hi:[1,0,1] neg_lo:[0,0,1] neg_hi:[0,0,1]
    v_pk_fma_f32 v[170:171], v[168:169], v[190:191], v[166:167] op_sel_hi:[1,0,1] neg_lo:[0,0,1] neg_hi:[0,0,1]
    v_cvt_pk_bf16_f32 v57, v164, v166
    v_cvt_pk_bf16_f32 v89, v165, v167
    v_pk_fma_f32 v[172:173], v[170:171], v[190:191], v[168:169] op_sel_hi:[1,0,1] neg_lo:[0,0,1] neg_hi:[0,0,1]
    v_pk_fma_f32 v[174:175], v[172:173], v[190:191], v[170:171] op_sel_hi:[1,0,1] neg_lo:[0,0,1] neg_hi:[0,0,1]
    v_cvt_pk_bf16_f32 v58, v168, v170
    v_cvt_pk_bf16_f32 v90, v169, v171
    v_cvt_pk_bf16_f32 v59, v172, v174
    v_cvt_pk_bf16_f32 v91, v173, v175
    v_pk_add_f32 v[162:163], v[228:229], v[230:231] op_sel_hi:[1,0]
    v_cos_f32 v160, v228
    v_cos_f32 v161, v229
    v_cos_f32 v162, v162
    v_cos_f32 v163, v163
    s_nop 0
    v_pk_fma_f32 v[164:165], v[162:163], v[190:191], v[160:161] op_sel_hi:[1,0,1] neg_lo:[0,0,1] neg_hi:[0,0,1]
    v_pk_fma_f32 v[166:167], v[164:165], v[190:191], v[162:163] op_sel_hi:[1,0,1] neg_lo:[0,0,1] neg_hi:[0,0,1]
    v_cvt_pk_bf16_f32 v60, v160, v162
    v_cvt_pk_bf16_f32 v92, v161, v163
    v_pk_fma_f32 v[168:169], v[166:167], v[190:191], v[164:165] op_sel_hi:[1,0,1] neg_lo:[0,0,1] neg_hi:[0,0,1]
    v_pk_fma_f32 v[170:171], v[168:169], v[190:191], v[166:167] op_sel_hi:[1,0,1] neg_lo:[0,0,1] neg_hi:[0,0,1]
    v_cvt_pk_bf16_f32 v61, v164, v166
    v_cvt_pk_bf16_f32 v93, v165, v167
    v_pk_fma_f32 v[172:173], v[170:171], v[190:191], v[168:169] op_sel_hi:[1,0,1] neg_lo:[0,0,1] neg_hi:[0,0,1]
    v_pk_fma_f32 v[174:175], v[172:173], v[190:191], v[170:171] op_sel_hi:[1,0,1] neg_lo:[0,0,1] neg_hi:[0,0,1]
    v_cvt_pk_bf16_f32 v62, v168, v170
    v_cvt_pk_bf16_f32 v94, v169, v171
    v_cvt_pk_bf16_f32 v63, v172, v174
    v_cvt_pk_bf16_f32 v95, v173, v175
L_APOLL:
    s_mov_b64 exec, 0xffff
    s_waitcnt vmcnt(0)
    v_xor_b32 v208, s35, v208
    v_xor_b32 v209, s35, v209
    v_xor_b32 v210, s35, v210
    v_xor_b32 v211, s35, v211
    v_or_b32 v208, v208, v209
    v_or3_b32 v208, v208, v210, v211
    v_cmp_ne_u32 vcc, 0, v208
    s_sub_u32 s41, s41, 1
    s_cmp_eq_u32 s41, 0
    s_cbranch_scc1 L_AREADY
    s_nop 1
    s_cbranch_vccnz L_ARETRY
L_AREADY:
    s_mov_b64 exec, -1
    s_add_u32 m0, s34, 5632
    s_mov_b32 exec_hi, 0
    buffer_load_dwordx4 v3, s[44:47], s96 offen lds
    s_mov_b32 exec_hi, -1
    buffer_load_dwordx4 v[96:99], v2, s[44:47], s96 offen
    s_add_u32 s96, s96, 4224
    buffer_load_dwordx4 v[100:103], v2, s[44:47], s96 offen
    s_add_u32 s96, s96, 4224
    buffer_load_dwordx4 v[104:107], v2, s[44:47], s96 offen
    s_add_u32 s96, s96, 4224
    buffer_load_dwordx4 v[108:111], v2, s[44:47], s96 offen
    s_add_u32 s96, s96, 4224
    buffer_load_dwordx4 v[112:115], v2, s[44:47], s96 offen
    s_add_u32 s96, s96, 4224
    buffer_load_dwordx4 v[116:119], v2, s[44:47], s96 offen
    s_add_u32 s96, s96, 4224
    buffer_load_dwordx4 v[120:123], v2, s[44:47], s96 offen
    s_add_u32 s96, s96, 4224
    buffer_load_dwordx4 v[124:127], v2, s[44:47], s96 offen
    s_add_u32 s96, s96, 4224
    buffer_load_dwordx4 v[128:131], v2, s[44:47], s96 offen
    s_add_u32 s96, s96, 4224
    buffer_load_dwordx4 v[132:135], v2, s[44:47], s96 offen
    s_add_u32 s96, s96, 4224
    buffer_load_dwordx4 v[136:139], v2, s[44:47], s96 offen
    s_add_u32 s96, s96, 4224
    buffer_load_dwordx4 v[140:143], v2, s[44:47], s96 offen
    s_add_u32 s96, s96, 4224
    buffer_load_dwordx4 v[144:147], v2, s[44:47], s96 offen
    s_add_u32 s96, s96, 4224
    buffer_load_dwordx4 v[148:151], v2, s[44:47], s96 offen
    s_add_u32 s96, s96, 4224
    buffer_load_dwordx4 v[152:155], v2, s[44:47], s96 offen
    s_add_u32 s96, s96, 4224
    buffer_load_dwordx4 v[156:159], v2, s[44:47], s96 offen
    buffer_load_dword v4, v4, s[44:47], 0 offen sc1
L_AGO:
    v_and_b32 v208, 15, v1
    v_lshlrev_b32 v6, 8, v205
    v_add_u32 v6, 5632, v6
    v_bfe_u32 v209, v1, 2, 1
    v_bfe_u32 v210, v1, 4, 1
    v_cmp_eq_u32 vcc, v209, v210
    v_mov_b32 v209, 6656
    v_lshl_add_u32 v211, v1, 2, s34
    v_cndmask_b32 v6, v209, v6, vcc
    v_add_u32 v6, s34, v6
    v_mov_b32 v209, 0
    ds_write_b32 v211, v209 offset:6656
    s_mov_b64 s[14:15], vcc
    v_and_b32 v207, 7, v1
    v_xor_b32 v207, v207, v205
    v_lshlrev_b32 v7, 7, v204
    v_lshl_add_u32 v7, v207, 4, v7
    v_add_u32 v7, s34, v7
    s_lshl_b32 s41, s33, 2
    v_lshrrev_b32 v204, 4, v1
    v_add_u32 v204, s41, v204
    v_and_b32 v205, 14, v204
    v_lshl_add_u32 v205, v205, 1, s0
    v_and_b32 v206, 1, v204
    v_cmp_eq_u32 vcc, 1, v206
    v_sub_u32 v207, 1024, v205
    v_mov_b32 v209, 32
    v_mov_b32 v210, -32
    v_cndmask_b32 v207, v205, v207, vcc
    v_cndmask_b32 v209, v209, v210, vcc
    v_add_u32 v209, v209, v207
    v_sub_u32 v210, 2048, v207
    v_sub_u32 v211, 2048, v209
    v_cmp_eq_u32 vcc, 0, v205
    v_lshlrev_b32 v206, 9, v206
    v_add_u32 v212, 1024, v206
    v_cndmask_b32 v207, v207, v206, vcc
    v_cndmask_b32 v210, v210, v212, vcc
    v_lshrrev_b32 v206, 1, v207
    v_xor_b32 v206, s1, v206
    v_lshlrev_b32 v206, 31, v206
    v_or_b32 v13, 1.0, v206
    s_lshl_b32 s40, s39, 6
    s_sub_u32 s41, 896, s40
    v_cmp_gt_u32 vcc, 8, v208
    v_mov_b32 v212, s41
    v_mov_b32 v213, s40
    v_cndmask_b32 v212, v212, v213, vcc
    v_lshl_add_u32 v212, v208, 3, v212
    v_lshl_add_u32 v16, v207, 10, v212
    v_lshl_add_u32 v17, v210, 10, v212
    v_lshl_add_u32 v18, v209, 10, v212
    v_lshl_add_u32 v19, v211, 10, v212
    s_mov_b64 s[12:13], vcc
    s_mov_b32 s52, s22
    s_and_b32 s53, s23, 0xffff
    s_mov_b32 s54, 1024
    s_mov_b32 s55, 0x20000
    buffer_load_dwordx2 v[20:21], v16, s[48:51], 0 offen
    buffer_load_dwordx2 v[22:23], v17, s[48:51], 0 offen
    buffer_load_dwordx2 v[24:25], v18, s[48:51], 0 offen
    buffer_load_dwordx2 v[26:27], v19, s[48:51], 0 offen
    buffer_load_dwordx2 v[28:29], v212, s[52:55], 0 offen
    v_cndmask_b32 v8, -1.0, 1.0, vcc
    v_and_b32 v210, 7, v204
    v_xor_b32 v211, v208, v210
    v_lshlrev_b32 v205, 8, v204
    v_lshl_add_u32 v11, v211, 4, v205
    v_lshlrev_b32 v205, 7, v204
    v_add_u32 v205, 131072, v205
    v_sub_u32 v211, 15, v208
    v_cndmask_b32 v211, v211, v208, vcc
    v_xor_b32 v211, v211, v210
    v_lshl_add_u32 v9, v211, 4, v205
    v_sub_u32 v211, 16, v208
    v_and_b32 v207, 7, v211
    v_cmp_eq_u32 vcc, 8, v211
    v_xor_b32 v207, v207, v210
    v_lshl_add_u32 v10, v207, 4, v205
    v_lshlrev_b32 v206, 2, v204
    v_add_u32 v206, 137984, v206
    v_add_u32 v209, 2048, v10
    v_add_u32 v207, 64, v206
    v_cndmask_b32 v10, v10, v206, vcc
    v_cndmask_b32 v3, v209, v207, vcc
    s_lshl_b32 s40, s1, 14
    s_add_u32 s40, s40, 138240
    v_lshl_add_u32 v12, v208, 4, s40
    s_waitcnt vmcnt(22)
    s_waitcnt lgkmcnt(0)
    ds_read_b128 v[188:191], v6
    ds_read_b128 v[192:195], v6 offset:16
    s_waitcnt vmcnt(21)
    v_mfma_f32_32x32x16_bf16 v[160:175], v[96:99], v[32:35], 0
    s_waitcnt lgkmcnt(1)
    v_mfma_f32_16x16x32_bf16 v[176:179], v[188:191], v[32:35], 0
    ds_read_b128 v[188:191], v6 offset:32
    s_waitcnt vmcnt(20)
    v_mfma_f32_32x32x16_bf16 v[160:175], v[100:103], v[36:39], v[160:175]
    s_waitcnt lgkmcnt(1)
    v_mfma_f32_16x16x32_bf16 v[176:179], v[192:195], v[36:39], v[176:179]
    ds_read_b128 v[192:195], v6 offset:48
    s_waitcnt vmcnt(19)
    v_mfma_f32_32x32x16_bf16 v[160:175], v[104:107], v[40:43], v[160:175]
    s_waitcnt lgkmcnt(1)
    v_mfma_f32_16x16x32_bf16 v[176:179], v[188:191], v[40:43], v[176:179]
    ds_read_b128 v[188:191], v6 offset:64
    s_waitcnt vmcnt(18)
    v_mfma_f32_32x32x16_bf16 v[160:175], v[108:111], v[44:47], v[160:175]
    s_waitcnt lgkmcnt(1)
    v_mfma_f32_16x16x32_bf16 v[176:179], v[192:195], v[44:47], v[176:179]
    ds_read_b128 v[192:195], v6 offset:80
    s_waitcnt vmcnt(17)
    v_mfma_f32_32x32x16_bf16 v[160:175], v[112:115], v[48:51], v[160:175]
    s_waitcnt lgkmcnt(1)
    v_mfma_f32_16x16x32_bf16 v[176:179], v[188:191], v[48:51], v[176:179]
    ds_read_b128 v[188:191], v6 offset:96
    s_waitcnt vmcnt(16)
    v_mfma_f32_32x32x16_bf16 v[160:175], v[116:119], v[52:55], v[160:175]
    s_waitcnt lgkmcnt(1)
    v_mfma_f32_16x16x32_bf16 v[176:179], v[192:195], v[52:55], v[176:179]
    ds_read_b128 v[192:195], v6 offset:112
    s_waitcnt vmcnt(15)
    v_mfma_f32_32x32x16_bf16 v[160:175], v[120:123], v[56:59], v[160:175]
    s_waitcnt lgkmcnt(1)
    v_mfma_f32_16x16x32_bf16 v[176:179], v[188:191], v[56:59], v[176:179]
    ds_read_b128 v[188:191], v6 offset:128
    s_waitcnt vmcnt(14)
    v_mfma_f32_32x32x16_bf16 v[160:175], v[124:127], v[60:63], v[160:175]
    s_waitcnt lgkmcnt(1)
    v_mfma_f32_16x16x32_bf16 v[176:179], v[192:195], v[60:63], v[176:179]
    ds_read_b128 v[192:195], v6 offset:144
    s_waitcnt vmcnt(13)
    v_mfma_f32_32x32x16_bf16 v[160:175], v[128:131], v[64:67], v[160:175]
    s_waitcnt lgkmcnt(1)
    v_mfma_f32_16x16x32_bf16 v[176:179], v[188:191], v[64:67], v[176:179]
    ds_read_b128 v[188:191], v6 offset:160
    s_waitcnt vmcnt(12)
    v_mfma_f32_32x32x16_bf16 v[160:175], v[132:135], v[68:71], v[160:175]
    s_waitcnt lgkmcnt(1)
    v_mfma_f32_16x16x32_bf16 v[176:179], v[192:195], v[68:71], v[176:179]
    ds_read_b128 v[192:195], v6 offset:176
    s_waitcnt vmcnt(11)
    v_mfma_f32_32x32x16_bf16 v[160:175], v[136:139], v[72:75], v[160:175]
    s_waitcnt lgkmcnt(1)
    v_mfma_f32_16x16x32_bf16 v[176:179], v[188:191], v[72:75], v[176:179]
    ds_read_b128 v[188:191], v6 offset:192
    s_waitcnt vmcnt(10)
    v_mfma_f32_32x32x16_bf16 v[160:175], v[140:143], v[76:79], v[160:175]
    s_waitcnt lgkmcnt(1)
    v_mfma_f32_16x16x32_bf16 v[176:179], v[192:195], v[76:79], v[176:179]
    ds_read_b128 v[192:195], v6 offset:208
    s_waitcnt vmcnt(9)
    v_mfma_f32_32x32x16_bf16 v[160:175], v[144:147], v[80:83], v[160:175]
    s_waitcnt lgkmcnt(1)
    v_mfma_f32_16x16x32_bf16 v[176:179], v[188:191], v[80:83], v[176:179]
    ds_read_b128 v[188:191], v6 offset:224
    s_waitcnt vmcnt(8)
    v_mfma_f32_32x32x16_bf16 v[160:175], v[148:151], v[84:87], v[160:175]
    s_waitcnt lgkmcnt(1)
    v_mfma_f32_16x16x32_bf16 v[176:179], v[192:195], v[84:87], v[176:179]
    ds_read_b128 v[192:195], v6 offset:240
    s_waitcnt vmcnt(7)
    v_mfma_f32_32x32x16_bf16 v[160:175], v[152:155], v[88:91], v[160:175]
    s_waitcnt lgkmcnt(1)
    v_mfma_f32_16x16x32_bf16 v[176:179], v[188:191], v[88:91], v[176:179]
    s_waitcnt vmcnt(6)
    v_mfma_f32_32x32x16_bf16 v[160:175], v[156:159], v[92:95], v[160:175]
    s_waitcnt lgkmcnt(0)
    v_mfma_f32_16x16x32_bf16 v[176:179], v[192:195], v[92:95], v[176:179]
    s_lshr_b32 s40, s33, 1
    s_or_b32 s40, s40, s31
    s_or_b32 s40, s40, s38
    s_cmp_lg_u32 s40, 0
    s_cbranch_scc0 Lalt_40_c
Lalt_40:
    v_xor_b32 v205, 32, v7
    v_xor_b32 v206, 64, v7
    v_xor_b32 v207, 96, v7
    v_and_b32 v208, 31, v1
    v_lshl_add_u32 v208, v208, 2, s34
    v_lshl_add_u32 v209, v1, 2, s34
    v_mov_b32 v210, 163588
    v_mov_b32 v211, 1
    ds_write_b128 v7, v[160:163]
    ds_write_b128 v205, v[164:167]
    ds_write_b128 v206, v[168:171]
    ds_write_b128 v207, v[172:175]
    ds_write_b32 v208, v176 offset:6912
    s_waitcnt vmcnt(5)
    ds_write_b32 v209, v4 offset:7168
    s_waitcnt lgkmcnt(0)
    s_mov_b64 exec, 1
    ds_add_u32 v210, v211
    s_mov_b64 exec, -1
    s_mov_b32 s52, s24
    s_and_b32 s53, s25, 0xffff
    s_mov_b32 s54, 2097152
    s_mov_b32 s55, 0x20000
    s_mov_b32 s100, 0xbfb8aa3b
    s_mov_b32 s101, 1.0
    s_mov_b32 s41, 4000000
L_DSYNC:
    ds_read_b32 v211, v210
    s_waitcnt lgkmcnt(0)
    v_readfirstlane_b32 s40, v211
    s_sub_u32 s41, s41, 1
    s_cmp_eq_u32 s41, 0
    s_cbranch_scc1 L_DSYNCD
    s_cmp_lt_u32 s40, 4
    s_cbranch_scc1 L_DSYNC
L_DSYNCD:
    ds_read_b128 v[176:179], v12
    ds_read_b128 v[32:35], v9 offset:0
    ds_read_b128 v[36:39], v9 offset:8192
    ds_read_b128 v[40:43], v9 offset:16384
    ds_read_b128 v[44:47], v9 offset:24576
    ds_read2st64_b32 v[48:49], v10 offset0:0 offset1:32
    ds_read2st64_b32 v[50:51], v10 offset0:64 offset1:96
    ds_read_b128 v[56:59], v9 offset:2048
    ds_read_b128 v[60:63], v9 offset:10240
    ds_read_b128 v[64:67], v9 offset:18432
    ds_read_b128 v[68:71], v9 offset:26624
    ds_read2st64_b32 v[72:73], v3 offset0:0 offset1:32
    ds_read2st64_b32 v[74:75], v3 offset0:64 offset1:96
    s_cmp_eq_u32 s1, 0
    s_cselect_b64 vcc, -1, 0
    v_mul_f32 v182, v13, v8
    v_cndmask_b32 v182, v182, v13, vcc
    v_cndmask_b32 v180, -v182, v13, vcc
    s_waitcnt vmcnt(0)
    v_lshlrev_b32 v30, 16, v29
    v_and_b32 v31, 0xffff0000, v29
    v_and_b32 v29, 0xffff0000, v28
    v_lshlrev_b32 v28, 16, v28
    s_waitcnt lgkmcnt(6)
    v_pk_add_f32 v[32:33], v[32:33], v[36:37]
    v_pk_add_f32 v[34:35], v[34:35], v[38:39]
    v_pk_add_f32 v[40:41], v[40:41], v[44:45]
    v_pk_add_f32 v[42:43], v[42:43], v[46:47]
    v_add_f32 v48, v48, v49
    v_add_f32 v49, v50, v51
    v_cndmask_b32 v32, v48, v32, s[12:13]
    v_cndmask_b32 v50, v35, v33, s[12:13]
    v_cndmask_b32 v35, v33, v35, s[12:13]
    v_mov_b32 v33, v50
    v_cndmask_b32 v40, v49, v40, s[12:13]
    v_cndmask_b32 v50, v43, v41, s[12:13]
    v_cndmask_b32 v43, v41, v43, s[12:13]
    v_mov_b32 v41, v50
    v_pk_fma_f32 v[164:165], v[40:41], v[8:9], v[32:33] op_sel_hi:[1,0,1]
    v_pk_fma_f32 v[160:161], v[40:41], v[8:9], v[32:33] op_sel_hi:[1,0,1] neg_lo:[0,1,0] neg_hi:[0,1,0]
    v_pk_fma_f32 v[166:167], v[42:43], v[8:9], v[34:35] op_sel_hi:[1,0,1]
    v_pk_fma_f32 v[162:163], v[42:43], v[8:9], v[34:35] op_sel_hi:[1,0,1] neg_lo:[0,1,0] neg_hi:[0,1,0]
    v_pk_fma_f32 v[164:165], v[176:177], v[182:183], v[164:165] op_sel_hi:[1,0,1]
    v_pk_fma_f32 v[160:161], v[176:177], v[180:181], v[160:161] op_sel_hi:[1,0,1]
    v_pk_fma_f32 v[166:167], v[178:179], v[182:183], v[166:167] op_sel_hi:[1,0,1]
    v_pk_fma_f32 v[162:163], v[178:179], v[180:181], v[162:163] op_sel_hi:[1,0,1]
    s_waitcnt lgkmcnt(0)
    v_pk_add_f32 v[56:57], v[56:57], v[60:61]
    v_pk_add_f32 v[58:59], v[58:59], v[62:63]
    v_pk_add_f32 v[64:65], v[64:65], v[68:69]
    v_pk_add_f32 v[66:67], v[66:67], v[70:71]
    v_add_f32 v72, v72, v73
    v_add_f32 v73, v74, v75
    v_cndmask_b32 v56, v72, v56, s[12:13]
    v_cndmask_b32 v74, v59, v57, s[12:13]
    v_cndmask_b32 v59, v57, v59, s[12:13]
    v_mov_b32 v57, v74
    v_cndmask_b32 v64, v73, v64, s[12:13]
    v_cndmask_b32 v74, v67, v65, s[12:13]
    v_cndmask_b32 v67, v65, v67, s[12:13]
    v_mov_b32 v65, v74
    v_pk_fma_f32 v[172:173], v[64:65], v[8:9], v[56:57] op_sel_hi:[1,0,1]
    v_pk_fma_f32 v[168:169], v[64:65], v[8:9], v[56:57] op_sel_hi:[1,0,1] neg_lo:[0,1,0] neg_hi:[0,1,0]
    v_pk_fma_f32 v[174:175], v[66:67], v[8:9], v[58:59] op_sel_hi:[1,0,1]
    v_pk_fma_f32 v[170:171], v[66:67], v[8:9], v[58:59] op_sel_hi:[1,0,1] neg_lo:[0,1,0] neg_hi:[0,1,0]
    v_pk_fma_f32 v[172:173], v[176:177], v[182:183], v[172:173] op_sel_hi:[1,0,1]
    v_pk_fma_f32 v[168:169], v[176:177], v[180:181], v[168:169] op_sel_hi:[1,0,1]
    v_pk_fma_f32 v[174:175], v[178:179], v[182:183], v[174:175] op_sel_hi:[1,0,1]
    v_pk_fma_f32 v[170:171], v[178:179], v[180:181], v[170:171] op_sel_hi:[1,0,1]
    s_or_b32 s40, s31, s38
    s_or_b32 s40, s40, s33
    s_cmp_lg_u32 s40, 0
    s_cbranch_scc0 Lr1024_41_c
Lr1024_41:
    v_lshlrev_b32 v184, 16, v20
    v_and_b32 v185, 0xffff0000, v20
    v_lshlrev_b32 v186, 16, v21
    v_and_b32 v187, 0xffff0000, v21
    v_lshlrev_b32 v188, 16, v22
    v_and_b32 v189, 0xffff0000, v22
    v_lshlrev_b32 v190, 16, v23
    v_and_b32 v191, 0xffff0000, v23
    v_lshlrev_b32 v192, 16, v24
    v_and_b32 v193, 0xffff0000, v24
    v_lshlrev_b32 v194, 16, v25
    v_and_b32 v195, 0xffff0000, v25
    v_lshlrev_b32 v196, 16, v26
    v_and_b32 v197, 0xffff0000, v26
    v_lshlrev_b32 v198, 16, v27
    v_and_b32 v199, 0xffff0000, v27
    v_add_u32 v9, 65536, v11
    s_barrier
    ds_read_b128 v[32:35], v11 offset:16384
    ds_read_b128 v[36:39], v11 offset:49152
    ds_read_b128 v[40:43], v9 offset:16384
    ds_read_b128 v[44:47], v9 offset:49152
    ds_read_b128 v[48:51], v11 offset:24576
    ds_read_b128 v[52:55], v11 offset:57344
    ds_read_b128 v[56:59], v9 offset:24576
    ds_read_b128 v[60:63], v9 offset:57344
    ds_read_b128 v[64:67], v11 offset:20480
    ds_read_b128 v[68:71], v11 offset:53248
    ds_read_b128 v[72:75], v9 offset:20480
    ds_read_b128 v[76:79], v9 offset:53248
    ds_read_b128 v[80:83], v11 offset:28672
    ds_read_b128 v[84:87], v11 offset:61440
    ds_read_b128 v[88:91], v9 offset:28672
    ds_read_b128 v[92:95], v9 offset:61440
    s_waitcnt lgkmcnt(12)
    v_pk_add_f32 v[32:33], v[32:33], v[36:37]
    v_pk_add_f32 v[34:35], v[34:35], v[38:39]
    v_pk_add_f32 v[40:41], v[40:41], v[44:45]
    v_pk_add_f32 v[42:43], v[42:43], v[46:47]
    v_pk_add_f32 v[32:33], v[32:33], v[28:29]
    v_pk_add_f32 v[34:35], v[34:35], v[30:31]
    v_pk_add_f32 v[32:33], v[32:33], v[40:41]
    v_pk_add_f32 v[34:35], v[34:35], v[42:43]
    v_pk_mul_f32 v[36:37], v[32:33], s[100:101] op_sel_hi:[1,0]
    v_pk_mul_f32 v[38:39], v[34:35], s[100:101] op_sel_hi:[1,0]
    v_exp_f32 v36, v36
    v_exp_f32 v37, v37
    v_exp_f32 v38, v38
    v_exp_f32 v39, v39
    v_pk_mul_f32 v[160:161], v[160:161], v[32:33]
    v_pk_mul_f32 v[162:163], v[162:163], v[34:35]
    v_pk_add_f32 v[36:37], v[36:37], 1.0 op_sel_hi:[1,0]
    v_pk_add_f32 v[38:39], v[38:39], 1.0 op_sel_hi:[1,0]
    v_rcp_f32 v36, v36
    v_rcp_f32 v37, v37
    v_rcp_f32 v38, v38
    v_rcp_f32 v39, v39
    v_pk_fma_f32 v[160:161], v[160:161], v[36:37], v[184:185]
    v_pk_fma_f32 v[162:163], v[162:163], v[38:39], v[186:187]
    v_cvt_pk_bf16_f32 v36, v160, v161
    v_cvt_pk_bf16_f32 v37, v162, v163
    buffer_store_dwordx2 v[36:37], v16, s[52:55], 0 offen nt
    s_waitcnt lgkmcnt(8)
    v_pk_add_f32 v[48:49], v[48:49], v[52:53]
    v_pk_add_f32 v[50:51], v[50:51], v[54:55]
    v_pk_add_f32 v[56:57], v[56:57], v[60:61]
    v_pk_add_f32 v[58:59], v[58:59], v[62:63]
    v_pk_add_f32 v[48:49], v[48:49], v[28:29]
    v_pk_add_f32 v[50:51], v[50:51], v[30:31]
    v_pk_add_f32 v[48:49], v[48:49], v[56:57]
    v_pk_add_f32 v[50:51], v[50:51], v[58:59]
    v_pk_mul_f32 v[52:53], v[48:49], s[100:101] op_sel_hi:[1,0]
    v_pk_mul_f32 v[54:55], v[50:51], s[100:101] op_sel_hi:[1,0]
    v_exp_f32 v52, v52
    v_exp_f32 v53, v53
    v_exp_f32 v54, v54
    v_exp_f32 v55, v55
    v_pk_mul_f32 v[164:165], v[164:165], v[48:49]
    v_pk_mul_f32 v[166:167], v[166:167], v[50:51]
    v_pk_add_f32 v[52:53], v[52:53], 1.0 op_sel_hi:[1,0]
    v_pk_add_f32 v[54:55], v[54:55], 1.0 op_sel_hi:[1,0]
    v_rcp_f32 v52, v52
    v_rcp_f32 v53, v53
    v_rcp_f32 v54, v54
    v_rcp_f32 v55, v55
    v_pk_fma_f32 v[164:165], v[164:165], v[52:53], v[188:189]
    v_pk_fma_f32 v[166:167], v[166:167], v[54:55], v[190:191]
    v_cvt_pk_bf16_f32 v52, v164, v165
    v_cvt_pk_bf16_f32 v53, v166, v167
    buffer_store_dwordx2 v[52:53], v17, s[52:55], 0 offen nt
    s_waitcnt lgkmcnt(4)
    v_pk_add_f32 v[64:65], v[64:65], v[68:69]
    v_pk_add_f32 v[66:67], v[66:67], v[70:71]
    v_pk_add_f32 v[72:73], v[72:73], v[76:77]
    v_pk_add_f32 v[74:75], v[74:75], v[78:79]
    v_pk_add_f32 v[64:65], v[64:65], v[28:29]
    v_pk_add_f32 v[66:67], v[66:67], v[30:31]
    v_pk_add_f32 v[64:65], v[64:65], v[72:73]
    v_pk_add_f32 v[66:67], v[66:67], v[74:75]
    v_pk_mul_f32 v[68:69], v[64:65], s[100:101] op_sel_hi:[1,0]
    v_pk_mul_f32 v[70:71], v[66:67], s[100:101] op_sel_hi:[1,0]
    v_exp_f32 v68, v68
    v_exp_f32 v69, v69
    v_exp_f32 v70, v70
    v_exp_f32 v71, v71
    v_pk_mul_f32 v[168:169], v[168:169], v[64:65]
    v_pk_mul_f32 v[170:171], v[170:171], v[66:67]
    v_pk_add_f32 v[68:69], v[68:69], 1.0 op_sel_hi:[1,0]
    v_pk_add_f32 v[70:71], v[70:71], 1.0 op_sel_hi:[1,0]
    v_rcp_f32 v68, v68
    v_rcp_f32 v69, v69
    v_rcp_f32 v70, v70
    v_rcp_f32 v71, v71
    v_pk_fma_f32 v[168:169], v[168:169], v[68:69], v[192:193]
    v_pk_fma_f32 v[170:171], v[170:171], v[70:71], v[194:195]
    v_cvt_pk_bf16_f32 v68, v168, v169
    v_cvt_pk_bf16_f32 v69, v170, v171
    buffer_store_dwordx2 v[68:69], v18, s[52:55], 0 offen nt
    s_waitcnt lgkmcnt(0)
    v_pk_add_f32 v[80:81], v[80:81], v[84:85]
    v_pk_add_f32 v[82:83], v[82:83], v[86:87]
    v_pk_add_f32 v[88:89], v[88:89], v[92:93]
    v_pk_add_f32 v[90:91], v[90:91], v[94:95]
    v_pk_add_f32 v[80:81], v[80:81], v[28:29]
    v_pk_add_f32 v[82:83], v[82:83], v[30:31]
    v_pk_add_f32 v[80:81], v[80:81], v[88:89]
    v_pk_add_f32 v[82:83], v[82:83], v[90:91]
    v_pk_mul_f32 v[84:85], v[80:81], s[100:101] op_sel_hi:[1,0]
    v_pk_mul_f32 v[86:87], v[82:83], s[100:101] op_sel_hi:[1,0]
    v_exp_f32 v84, v84
    v_exp_f32 v85, v85
    v_exp_f32 v86, v86
    v_exp_f32 v87, v87
    v_pk_mul_f32 v[172:173], v[172:173], v[80:81]
    v_pk_mul_f32 v[174:175], v[174:175], v[82:83]
    v_pk_add_f32 v[84:85], v[84:85], 1.0 op_sel_hi:[1,0]
    v_pk_add_f32 v[86:87], v[86:87], 1.0 op_sel_hi:[1,0]
    v_rcp_f32 v84, v84
    v_rcp_f32 v85, v85
    v_rcp_f32 v86, v86
    v_rcp_f32 v87, v87
    v_pk_fma_f32 v[172:173], v[172:173], v[84:85], v[196:197]
    v_pk_fma_f32 v[174:175], v[174:175], v[86:87], v[198:199]
    v_cvt_pk_bf16_f32 v84, v172, v173
    v_cvt_pk_bf16_f32 v85, v174, v175
    buffer_store_dwordx2 v[84:85], v19, s[52:55], 0 offen nt
L_END:
    s_endpgm
L_MZ:
    v_mov_b32 v240, 0
    v_mov_b32 v241, 0
    v_mov_b32 v242, 0
    v_mov_b32 v243, 0
    v_mov_b32 v244, 0
    v_mov_b32 v245, 0
    v_mov_b32 v246, 0
    v_mov_b32 v247, 0
    v_mov_b32 v248, 0
    v_mov_b32 v249, 0
    v_mov_b32 v250, 0
    v_mov_b32 v251, 0
    v_mov_b32 v252, 0
    v_mov_b32 v253, 0
    v_mov_b32 v254, 0
    v_mov_b32 v255, 0
    s_branch L_MW
Lc_7:
    s_waitcnt lgkmcnt(1)
    v_mfma_f32_32x32x16_bf16 v[16:31], v[112:115], v[12:15], v[16:31]
    v_mfma_f32_32x32x16_bf16 v[32:47], v[116:119], v[12:15], v[32:47]
    ds_read_b128 v[8:11], v2 offset:10240
    s_waitcnt lgkmcnt(1)
    v_mfma_f32_32x32x16_bf16 v[48:63], v[112:115], v[4:7], v[48:63]
    v_mfma_f32_32x32x16_bf16 v[64:79], v[116:119], v[4:7], v[64:79]
    ds_read_b128 v[12:15], v2 offset:11264
    s_waitcnt lgkmcnt(1)
    v_mfma_f32_32x32x16_bf16 v[16:31], v[120:123], v[8:11], v[16:31]
    v_mfma_f32_32x32x16_bf16 v[32:47], v[124:127], v[8:11], v[32:47]
    ds_read_b128 v[4:7], v2 offset:12288
    s_waitcnt lgkmcnt(1)
    v_mfma_f32_32x32x16_bf16 v[48:63], v[120:123], v[12:15], v[48:63]
    v_mfma_f32_32x32x16_bf16 v[64:79], v[124:127], v[12:15], v[64:79]
    ds_read_b128 v[8:11], v2 offset:13312
    s_waitcnt lgkmcnt(1)
    v_mfma_f32_32x32x16_bf16 v[16:31], v[128:131], v[4:7], v[16:31]
    v_mfma_f32_32x32x16_bf16 v[32:47], v[132:135], v[4:7], v[32:47]
    ds_read_b128 v[12:15], v2 offset:14336
    s_waitcnt lgkmcnt(1)
    v_mfma_f32_32x32x16_bf16 v[48:63], v[128:131], v[8:11], v[48:63]
    v_mfma_f32_32x32x16_bf16 v[64:79], v[132:135], v[8:11], v[64:79]
    ds_read_b128 v[4:7], v2 offset:15360
    s_waitcnt lgkmcnt(1)
    v_mfma_f32_32x32x16_bf16 v[16:31], v[136:139], v[12:15], v[16:31]
    v_mfma_f32_32x32x16_bf16 v[32:47], v[140:143], v[12:15], v[32:47]
    s_waitcnt lgkmcnt(0)
    v_mfma_f32_32x32x16_bf16 v[48:63], v[136:139], v[4:7], v[48:63]
    v_mfma_f32_32x32x16_bf16 v[64:79], v[140:143], v[4:7], v[64:79]
    s_mov_b32 s41, 400000
Lhp_9:
    s_mov_b32 exec_lo, s95
    s_mov_b32 exec_hi, 0
    buffer_load_dwordx4 v[12:15], v3, s[44:47], 0 offen sc1
    s_waitcnt vmcnt(0)
    v_xor_b32 v12, s35, v12
    v_xor_b32 v13, s35, v13
    v_xor_b32 v14, s35, v14
    v_xor_b32 v15, s35, v15
    v_or_b32 v12, v12, v13
    v_or3_b32 v12, v12, v14, v15
    v_cmp_ne_u32 vcc, 0, v12
    s_mov_b64 exec, -1
    s_sub_u32 s41, s41, 1
    s_nop 2
    s_cselect_b32 s95, 0, vcc_lo
    s_and_b32 s40, s95, 240
    s_cbranch_scc1 Lhp_9
    s_add_u32 m0, s94, 16384
    s_add_u32 s93, s93, 4096
    buffer_load_dwordx4 v0, s[44:47], s93 offen offset:0 lds
    buffer_load_dwordx4 v0, s[44:47], s93 offen offset:1024 lds
    buffer_load_dwordx4 v0, s[44:47], s93 offen offset:2048 lds
    buffer_load_dwordx4 v0, s[44:47], s93 offen offset:3072 lds
    s_add_u32 m0, s94, 20480
    s_add_u32 s93, s93, 4096
    buffer_load_dwordx4 v0, s[44:47], s93 offen offset:0 lds
    buffer_load_dwordx4 v0, s[44:47], s93 offen offset:1024 lds
    buffer_load_dwordx4 v0, s[44:47], s93 offen offset:2048 lds
    buffer_load_dwordx4 v0, s[44:47], s93 offen offset:3072 lds
    s_add_u32 m0, s94, 24576
    s_add_u32 s93, s93, 4096
    buffer_load_dwordx4 v0, s[44:47], s93 offen offset:0 lds
    s_or_b32 exec_lo, s95, 1
    s_mov_b32 exec_hi, 0
    buffer_load_dwordx4 v[88:91], v3, s[44:47], 0 offen sc1
    s_mov_b64 exec, -1
    buffer_load_dwordx4 v0, s[44:47], s93 offen offset:1024 lds
    buffer_load_dwordx4 v0, s[44:47], s93 offen offset:2048 lds
    buffer_load_dwordx4 v0, s[44:47], s93 offen offset:3072 lds
    s_add_u32 m0, s94, 28672
    s_add_u32 s93, s93, 4096
    buffer_load_dwordx4 v0, s[44:47], s93 offen offset:0 lds
    buffer_load_dwordx4 v0, s[44:47], s93 offen offset:1024 lds
    buffer_load_dwordx4 v0, s[44:47], s93 offen offset:2048 lds
    buffer_load_dwordx4 v0, s[44:47], s93 offen offset:3072 lds
    s_waitcnt vmcnt(16)
    ds_read_b128 v[8:11], v2 offset:16384
    s_waitcnt vmcnt(15)
    ds_read_b128 v[12:15], v2 offset:17408
    s_branch Lj_8
Lc_11:
    s_waitcnt lgkmcnt(1)
    v_mfma_f32_32x32x16_bf16 v[16:31], v[152:155], v[4:7], v[16:31]
    v_mfma_f32_32x32x16_bf16 v[32:47], v[156:159], v[4:7], v[32:47]
    ds_read_b128 v[12:15], v2 offset:20480
    s_waitcnt lgkmcnt(1)
    v_mfma_f32_32x32x16_bf16 v[48:63], v[152:155], v[8:11], v[48:63]
    v_mfma_f32_32x32x16_bf16 v[64:79], v[156:159], v[8:11], v[64:79]
    ds_read_b128 v[4:7], v2 offset:21504
    s_waitcnt lgkmcnt(1)
    v_mfma_f32_32x32x16_bf16 v[16:31], v[160:163], v[12:15], v[16:31]
    v_mfma_f32_32x32x16_bf16 v[32:47], v[164:167], v[12:15], v[32:47]
    ds_read_b128 v[8:11], v2 offset:22528
    s_waitcnt lgkmcnt(1)
    v_mfma_f32_32x32x16_bf16 v[48:63], v[160:163], v[4:7], v[48:63]
    v_mfma_f32_32x32x16_bf16 v[64:79], v[164:167], v[4:7], v[64:79]
    ds_read_b128 v[12:15], v2 offset:23552
    s_waitcnt lgkmcnt(1)
    v_mfma_f32_32x32x16_bf16 v[16:31], v[168:171], v[8:11], v[16:31]
    v_mfma_f32_32x32x16_bf16 v[32:47], v[172:175], v[8:11], v[32:47]
    ds_read_b128 v[4:7], v2 offset:24576
    s_waitcnt lgkmcnt(1)
    v_mfma_f32_32x32x16_bf16 v[48:63], v[168:171], v[12:15], v[48:63]
    v_mfma_f32_32x32x16_bf16 v[64:79], v[172:175], v[12:15], v[64:79]
    s_waitcnt vmcnt(6)
    ds_read_b128 v[8:11], v2 offset:25600
    s_waitcnt lgkmcnt(1)
    v_mfma_f32_32x32x16_bf16 v[16:31], v[176:179], v[4:7], v[16:31]
    v_mfma_f32_32x32x16_bf16 v[32:47], v[180:183], v[4:7], v[32:47]
    s_waitcnt vmcnt(5)
    ds_read_b128 v[12:15], v2 offset:26624
    s_waitcnt lgkmcnt(1)
    v_mfma_f32_32x32x16_bf16 v[48:63], v[176:179], v[8:11], v[48:63]
    v_mfma_f32_32x32x16_bf16 v[64:79], v[180:183], v[8:11], v[64:79]
    s_waitcnt vmcnt(4)
    ds_read_b128 v[4:7], v2 offset:27648
    s_waitcnt lgkmcnt(1)
    v_mfma_f32_32x32x16_bf16 v[16:31], v[184:187], v[12:15], v[16:31]
    v_mfma_f32_32x32x16_bf16 v[32:47], v[188:191], v[12:15], v[32:47]
    s_waitcnt vmcnt(3)
    ds_read_b128 v[8:11], v2 offset:28672
    s_waitcnt lgkmcnt(1)
    v_mfma_f32_32x32x16_bf16 v[48:63], v[184:187], v[4:7], v[48:63]
    v_mfma_f32_32x32x16_bf16 v[64:79], v[188:191], v[4:7], v[64:79]
    s_waitcnt vmcnt(2)
    ds_read_b128 v[12:15], v2 offset:29696
    s_waitcnt lgkmcnt(1)
    v_mfma_f32_32x32x16_bf16 v[16:31], v[192:195], v[8:11], v[16:31]
    v_mfma_f32_32x32x16_bf16 v[32:47], v[196:199], v[8:11], v[32:47]
    s_waitcnt vmcnt(1)
    ds_read_b128 v[4:7], v2 offset:30720
    s_waitcnt lgkmcnt(1)
    v_mfma_f32_32x32x16_bf16 v[48:63], v[192:195], v[12:15], v[48:63]
    v_mfma_f32_32x32x16_bf16 v[64:79], v[196:199], v[12:15], v[64:79]
    s_waitcnt vmcnt(0)
    ds_read_b128 v[8:11], v2 offset:31744
    s_waitcnt lgkmcnt(1)
    v_mfma_f32_32x32x16_bf16 v[16:31], v[200:203], v[4:7], v[16:31]
    v_mfma_f32_32x32x16_bf16 v[32:47], v[204:207], v[4:7], v[32:47]
    s_waitcnt lgkmcnt(0)
    v_mfma_f32_32x32x16_bf16 v[48:63], v[200:203], v[8:11], v[48:63]
    v_mfma_f32_32x32x16_bf16 v[64:79], v[204:207], v[8:11], v[64:79]
    s_mov_b32 s41, 400000
Lhp_13:
    s_mov_b32 exec_lo, s95
    s_mov_b32 exec_hi, 0
    buffer_load_dwordx4 v[12:15], v3, s[44:47], 0 offen sc1
    s_waitcnt vmcnt(0)
    v_xor_b32 v12, s35, v12
    v_xor_b32 v13, s35, v13
    v_xor_b32 v14, s35, v14
    v_xor_b32 v15, s35, v15
    v_or_b32 v12, v12, v13
    v_or3_b32 v12, v12, v14, v15
    v_cmp_ne_u32 vcc, 0, v12
    s_mov_b64 exec, -1
    s_sub_u32 s41, s41, 1
    s_nop 2
    s_cselect_b32 s95, 0, vcc_lo
    s_and_b32 s40, s95, 1792
    s_cbranch_scc1 Lhp_13
    s_add_u32 m0, s94, 0
    s_add_u32 s93, s93, 4096
    buffer_load_dwordx4 v0, s[44:47], s93 offen offset:0 lds
    buffer_load_dwordx4 v0, s[44:47], s93 offen offset:1024 lds
    buffer_load_dwordx4 v0, s[44:47], s93 offen offset:2048 lds
    buffer_load_dwordx4 v0, s[44:47], s93 offen offset:3072 lds
    s_add_u32 m0, s94, 4096
    s_add_u32 s93, s93, 4096
    buffer_load_dwordx4 v0, s[44:47], s93 offen offset:0 lds
    buffer_load_dwordx4 v0, s[44:47], s93 offen offset:1024 lds
    buffer_load_dwordx4 v0, s[44:47], s93 offen offset:2048 lds
    buffer_load_dwordx4 v0, s[44:47], s93 offen offset:3072 lds
    s_add_u32 m0, s94, 8192
    s_cmp_lt_u32 s33, 3
    s_cselect_b32 s40, 4096, 0
    s_add_u32 s93, s93, s40
    buffer_load_dwordx4 v0, s[44:47], s93 offen offset:0 lds
    buffer_load_dwordx4 v0, s[44:47], s93 offen offset:1024 lds
    buffer_load_dwordx4 v0, s[44:47], s93 offen offset:2048 lds
    buffer_load_dwordx4 v0, s[44:47], s93 offen offset:3072 lds
    s_waitcnt vmcnt(11)
    ds_read_b128 v[12:15], v2 offset:0
    s_waitcnt vmcnt(9)
    ds_read_b128 v[4:7], v2 offset:2048
    s_branch Lj_12
Lc_15:
    s_mov_b32 s41, 400000
    s_waitcnt vmcnt(0)
    v_mov_b32 v252, v253
    s_branch Ltgp_17e
Ltgp_17:
    buffer_load_dword v252, off, s[56:59], 0 sc0 sc1
    s_waitcnt vmcnt(0)
Ltgp_17e:
    v_readfirstlane_b32 s35, v252
    s_sub_u32 s41, s41, 1
    s_cselect_b32 s35, 1, s35
    s_cmp_eq_u32 s35, 0
    s_cbranch_scc1 Ltgp_17
    s_nop 7
    s_nop 3
    s_branch Lj_16
Lc_20:
    s_mov_b64 exec, s[6:7]
    v_sub_f32 v204, v80, v83
    v_add_f32 v205, v80, v83
    v_fma_f32 v88, v239, v81, v82
    s_lshl_b32 s40, s38, 11
    s_lshl_b32 s41, s39, 7
    s_add_u32 s40, s40, s41
    v_lshl_add_u32 v89, v1, 2, s40
    v_mov_b32 v90, 1024
    v_cndmask_b32 v89, v89, v90, s[8:9]
    s_mov_b32 s40, 393216
    buffer_store_dword v88, v89, s[44:47], s40 offen sc1
    s_and_b64 exec, exec, s[8:9]
    v_mov_b32 v91, 0
    v_mov_b32 v207, 2048
    buffer_store_dword v91, v207, s[44:47], s40 offen sc1
    buffer_store_dword v91, v207, s[44:47], s40 offen offset:1024 sc1
    s_mov_b64 exec, -1
    s_branch Lj_21
Lc_22:
    buffer_store_dwordx4 v[216:219], v233, s[44:47], s88 offen offset:0 sc1
    s_branch Lj_23
Lc_24:
    buffer_store_dwordx4 v[220:223], v233, s[44:47], s88 offen offset:2048 sc1
    s_branch Lj_25
Lc_26:
    buffer_store_dwordx4 v[224:227], v233, s[44:47], s89 offen offset:0 sc1
    s_branch Lj_27
Lc_28:
    buffer_store_dword v255, off, s[44:47], s91 sc0 sc1
    s_branch Lj_29
Lc_30:
    buffer_store_dwordx4 v[216:219], v233, s[44:47], s89 offen offset:2048 sc1
    s_branch Lj_31
Lc_32:
    buffer_store_dwordx4 v[220:223], v233, s[44:47], s90 offen offset:0 sc1
    s_branch Lj_33
Lc_34:
    buffer_store_dword v255, off, s[44:47], s92 sc0 sc1
    s_branch Lj_35
Lc_36:
    buffer_store_dwordx4 v[224:227], v233, s[44:47], s90 offen offset:2048 sc1
    s_branch Lj_37
Lc_38:
    buffer_store_dword v255, off, s[44:47], s92 sc0 sc1
    s_branch Lj_39
L_ARETRY:
    buffer_load_dwordx4 v[208:211], v5, s[44:47], 0 offen sc1
    s_branch L_APOLL
Lwfok_3_c:
    buffer_load_dword v25, v24, s[44:47], 0 offen sc1
    s_waitcnt vmcnt(0)
    s_sub_u32 s41, s41, 1
    s_cmp_lg_u32 s41, 0
    s_cbranch_scc1 Lwfp_4
    s_nop 7
    s_nop 3
    s_branch Lwfok_3
Lrecok_18_c:
    buffer_load_dwordx2 v[252:253], v254, s[44:47], s99 offen sc1
    buffer_load_dwordx4 v[244:247], v243, s[44:47], s98 offen offset:16 sc1
    buffer_load_dwordx4 v[248:251], v243, s[44:47], s98 offen sc1
    s_waitcnt vmcnt(0)
    s_sub_u32 s42, s42, 1
    s_cmp_lg_u32 s42, 0
    s_cbranch_scc1 Lrecp_19
    s_nop 7
    s_nop 3
    s_branch Lrecok_18
Lalt_40_c:
    ds_read_b128 v[188:191], v6
    ds_read_b128 v[192:195], v6 offset:16
    v_mov_b32 v208, 0x3f803f80
    v_mov_b32 v209, 0x3f803f80
    v_mov_b32 v210, 0x3f803f80
    v_mov_b32 v211, 0x3f803f80
    v_cndmask_b32 v204, 0, v208, s[14:15]
    v_cndmask_b32 v205, 0, v208, s[14:15]
    v_cndmask_b32 v206, 0, v208, s[14:15]
    v_cndmask_b32 v207, 0, v208, s[14:15]
    s_nop 1
    v_mfma_f32_16x16x32_bf16 v[180:183], v[204:207], v[96:99], 0
    s_waitcnt lgkmcnt(1)
    v_mfma_f32_16x16x32_bf16 v[184:187], v[188:191], v[208:211], 0
    ds_read_b128 v[188:191], v6 offset:32
    v_mfma_f32_16x16x32_bf16 v[180:183], v[204:207], v[100:103], v[180:183]
    s_waitcnt lgkmcnt(1)
    v_mfma_f32_16x16x32_bf16 v[184:187], v[192:195], v[208:211], v[184:187]
    ds_read_b128 v[192:195], v6 offset:48
    v_mfma_f32_16x16x32_bf16 v[180:183], v[204:207], v[104:107], v[180:183]
    s_waitcnt lgkmcnt(1)
    v_mfma_f32_16x16x32_bf16 v[184:187], v[188:191], v[208:211], v[184:187]
    ds_read_b128 v[188:191], v6 offset:64
    v_mfma_f32_16x16x32_bf16 v[180:183], v[204:207], v[108:111], v[180:183]
    s_waitcnt lgkmcnt(1)
    v_mfma_f32_16x16x32_bf16 v[184:187], v[192:195], v[208:211], v[184:187]
    ds_read_b128 v[192:195], v6 offset:80
    v_mfma_f32_16x16x32_bf16 v[180:183], v[204:207], v[112:115], v[180:183]
    s_waitcnt lgkmcnt(1)
    v_mfma_f32_16x16x32_bf16 v[184:187], v[188:191], v[208:211], v[184:187]
    ds_read_b128 v[188:191], v6 offset:96
    v_mfma_f32_16x16x32_bf16 v[180:183], v[204:207], v[116:119], v[180:183]
    s_waitcnt lgkmcnt(1)
    v_mfma_f32_16x16x32_bf16 v[184:187], v[192:195], v[208:211], v[184:187]
    ds_read_b128 v[192:195], v6 offset:112
    v_mfma_f32_16x16x32_bf16 v[180:183], v[204:207], v[120:123], v[180:183]
    s_waitcnt lgkmcnt(1)
    v_mfma_f32_16x16x32_bf16 v[184:187], v[188:191], v[208:211], v[184:187]
    ds_read_b128 v[188:191], v6 offset:128
    v_mfma_f32_16x16x32_bf16 v[180:183], v[204:207], v[124:127], v[180:183]
    s_waitcnt lgkmcnt(1)
    v_mfma_f32_16x16x32_bf16 v[184:187], v[192:195], v[208:211], v[184:187]
    ds_read_b128 v[192:195], v6 offset:144
    s_nop 7
    v_xor_b32 v204, 0x80008000, v204
    v_xor_b32 v205, 0x80008000, v205
    v_xor_b32 v206, 0x80008000, v206
    v_xor_b32 v207, 0x80008000, v207
    v_xor_b32 v208, 0x80008000, v208
    v_xor_b32 v209, 0x80008000, v209
    v_xor_b32 v210, 0x80008000, v210
    v_xor_b32 v211, 0x80008000, v211
    v_mfma_f32_16x16x32_bf16 v[180:183], v[204:207], v[128:131], v[180:183]
    s_waitcnt lgkmcnt(1)
    v_mfma_f32_16x16x32_bf16 v[184:187], v[188:191], v[208:211], v[184:187]
    ds_read_b128 v[188:191], v6 offset:160
    v_mfma_f32_16x16x32_bf16 v[180:183], v[204:207], v[132:135], v[180:183]
    s_waitcnt lgkmcnt(1)
    v_mfma_f32_16x16x32_bf16 v[184:187], v[192:195], v[208:211], v[184:187]
    ds_read_b128 v[192:195], v6 offset:176
    v_mfma_f32_16x16x32_bf16 v[180:183], v[204:207], v[136:139], v[180:183]
    s_waitcnt lgkmcnt(1)
    v_mfma_f32_16x16x32_bf16 v[184:187], v[188:191], v[208:211], v[184:187]
    ds_read_b128 v[188:191], v6 offset:192
    v_mfma_f32_16x16x32_bf16 v[180:183], v[204:207], v[140:143], v[180:183]
    s_waitcnt lgkmcnt(1)
    v_mfma_f32_16x16x32_bf16 v[184:187], v[192:195], v[208:211], v[184:187]
    ds_read_b128 v[192:195], v6 offset:208
    v_mfma_f32_16x16x32_bf16 v[180:183], v[204:207], v[144:147], v[180:183]
    s_waitcnt lgkmcnt(1)
    v_mfma_f32_16x16x32_bf16 v[184:187], v[188:191], v[208:211], v[184:187]
    ds_read_b128 v[188:191], v6 offset:224
    v_mfma_f32_16x16x32_bf16 v[180:183], v[204:207], v[148:151], v[180:183]
    s_waitcnt lgkmcnt(1)
    v_mfma_f32_16x16x32_bf16 v[184:187], v[192:195], v[208:211], v[184:187]
    ds_read_b128 v[192:195], v6 offset:240
    v_mfma_f32_16x16x32_bf16 v[180:183], v[204:207], v[152:155], v[180:183]
    s_waitcnt lgkmcnt(1)
    v_mfma_f32_16x16x32_bf16 v[184:187], v[188:191], v[208:211], v[184:187]
    v_mfma_f32_16x16x32_bf16 v[180:183], v[204:207], v[156:159], v[180:183]
    s_waitcnt lgkmcnt(0)
    v_mfma_f32_16x16x32_bf16 v[184:187], v[192:195], v[208:211], v[184:187]
    v_and_b32 v212, 31, v1
    v_cmp_eq_u32 vcc, 0, v212
    v_lshl_add_u32 v213, v212, 2, s34
    v_sub_u32 v212, 32, v212
    v_and_b32 v212, 31, v212
    v_lshl_add_u32 v212, v212, 2, s34
    ds_write_b32 v213, v180 offset:7424
    s_nop 0
    v_cndmask_b32 v214, v180, v184, vcc
    ds_write_b32 v212, v214 offset:7552
    s_nop 7
    s_nop 3
    s_branch Lalt_40
Lr1024_41_c:
    ds_read_b128 v[32:35], v12 offset:256
    s_waitcnt lgkmcnt(0)
    v_pk_add_f32 v[176:177], v[176:177], v[32:33]
    v_pk_add_f32 v[178:179], v[178:179], v[34:35]
    ds_read_b128 v[32:35], v12 offset:8448
    s_waitcnt lgkmcnt(0)
    v_pk_add_f32 v[176:177], v[176:177], v[32:33]
    v_pk_add_f32 v[178:179], v[178:179], v[34:35]
    s_mov_b64 exec, 0xffff
    v_mov_b32 v164, v176
    v_mov_b32 v165, v177
    v_mov_b32 v166, v178
    v_mov_b32 v167, v179
    s_mov_b64 exec, -1
    s_nop 7
    s_nop 3
    s_branch Lr1024_41
L_FIN:
.section .rodata,"a"
.p2align 6
.amdhsa_kernel recurrent_scan__spectral_fnet__mixer_channel_mlp__prompt_kernel
  .amdhsa_next_free_vgpr 256
  .amdhsa_next_free_sgpr 102
  .amdhsa_accum_offset 256
  .amdhsa_group_segment_fixed_size 0
  .amdhsa_kernarg_size 104
  .amdhsa_user_sgpr_count 2
  .amdhsa_user_sgpr_kernarg_segment_ptr 1
  .amdhsa_system_sgpr_workgroup_id_x 1
.end_amdhsa_kernel
```
